```python
import torch

def _softmax(x, axis=-1):
    return torch.softmax(x, dim=axis)
def _gelu(x):
    return torch.nn.functional.gelu(x, approximate="tanh")
def _silu(x):
    return torch.nn.functional.silu(x)
def _sigmoid(x):
    return torch.sigmoid(x)
def _layernorm(x, axis=-1, eps=1e-5):
    m = x.mean(dim=axis, keepdim=True)
    v = x.var(dim=axis, keepdim=True, unbiased=False)
    return (x - m) / torch.sqrt(v + eps)
def _scatter_add(tgt, idx, src, axis=0):
    return tgt.clone().index_add_(axis, idx, src)
def _segment_sum(src, seg, n):
    out = torch.zeros((n,) + src.shape[1:], dtype=src.dtype)
    return out.index_add_(0, seg, src)
def _pad(x, pw):
    flat = tuple(v for pair in reversed(pw) for v in pair)
    return torch.nn.functional.pad(x, flat)

kernel_name = 'parallel_sum__sliding_local_dilated__mixer_s_mlp__prompt'

def setup_inputs():

    _w = (lambda a: (lambda t: t.to(torch.bfloat16) if t.is_floating_point() else t)(torch.as_tensor(a)))
    def _A_setup():
        B, S, D = 1, 2048, 1024
        return {
            "x": _w((lambda *s: torch.randn(*s, dtype=torch.bfloat16) * 0.05)(B, S, D)),
            "wqkv": _w((lambda *s: torch.randn(*s, dtype=torch.bfloat16) * 0.05)(D, 3 * D)),
            "wo": _w((lambda *s: torch.randn(*s, dtype=torch.bfloat16) * 0.05)(D, D)),
        }
    _A_in = _A_setup()

    def _B_setup():
        B, S, D, F = 1, 2048, 1024, 3584
        return {
            "x":  _w((lambda *s: torch.randn(*s, dtype=torch.bfloat16) * 0.05)(B, S, D)),
            "w1": _w((lambda *s: torch.randn(*s, dtype=torch.bfloat16) * 3.2)(D, D) * (D ** -0.5)),
            "w2": _w((lambda *s: torch.randn(*s, dtype=torch.bfloat16) * 3.2)(D, D) * (D ** -0.5)),
            "w3": _w((lambda *s: torch.randn(*s, dtype=torch.bfloat16) * 3.2)(D, F) * (D ** -0.5)),
            "w4": _w((lambda *s: torch.randn(*s, dtype=torch.bfloat16) * 1.6)(F, D) * (F ** -0.5)),
        }
    _B_in = _B_setup()

    return {
        "A_x": _A_in["x"],
        "A_wqkv": _A_in["wqkv"],
        "A_wo": _A_in["wo"],
        "B_x": _B_in["x"],
        "B_w1": _B_in["w1"],
        "B_w2": _B_in["w2"],
        "B_w3": _B_in["w3"],
        "B_w4": _B_in["w4"],
    }

def reference(A_x, A_wqkv, A_wo, B_x, B_w1, B_w2, B_w3, B_w4):
    def _A_ref(x, wqkv, wo):
        B, S, D = x.shape
        H = 32; Dh = D // H
        W, dil = 8, 2
        qkv = (lambda x, *d: x.permute(*d))((x @ wqkv).reshape(B, S, 3, H, Dh), 2, 0, 3, 1, 4)
        q, k, v = qkv[0], qkv[1], qkv[2]
        scale = Dh ** -0.5
        pos = torch.arange(S)
        off = torch.arange(W) * dil
        idx = pos[:, None] - off[None, :]
        mask = idx >= 0
        idx_c = torch.where(mask, idx, 0).reshape(-1)
        kg = k[:, :, idx_c, :].reshape(B, H, S, W, Dh)
        vg = v[:, :, idx_c, :].reshape(B, H, S, W, Dh)
        logits = torch.einsum("bhsd,bhswd->bhsw", q, kg) * scale
        logits = torch.where(mask[None, None, :, :], logits, -1e9)
        attn = _softmax(logits, axis=-1)
        o = torch.einsum("bhsw,bhswd->bhsd", attn, vg)
        return (lambda x, *d: x.permute(*d))(o, 0, 2, 1, 3).reshape(B, S, D) @ wo

    def _B_ref(x, w1, w2, w3, w4):
        B, S, D = x.shape
        h = _gelu(_layernorm(x, axis=-1) @ w1)
        c = D // 4
        g0 = _pad(h[:, :, 0*c:1*c], ((0, 0), (1, 0), (0, 0)))[:, :S, :]
        g1 = _pad(h[:, :, 1*c:2*c], ((0, 0), (0, 1), (0, 0)))[:, 1:, :]
        g2 = _pad(h[:, :, 2*c:3*c], ((0, 0), (2, 0), (0, 0)))[:, :S, :]
        g3 = _pad(h[:, :, 3*c:   ], ((0, 0), (0, 2), (0, 0)))[:, 2:, :]
        hs = torch.concatenate([g0, g1, g2, g3], axis=-1) @ w2
        x1 = x + hs
        h2 = _gelu(_layernorm(x1, axis=-1) @ w3) @ w4
        return x1 + h2

    x = A_x
    xn = _layernorm(x, axis=-1)
    return x + _A_ref(xn, A_wqkv, A_wo) + _B_ref(xn, B_w1, B_w2, B_w3, B_w4)
```

```asm
; @launch kernel=m_kernel grid=(256,1,1) block=(512,1,1) lds=163840
.amdgcn_target "amdgcn-amd-amdhsa--gfx950"
.text
.globl m_kernel
.p2align 8
.type m_kernel,@function
m_kernel:
    s_cmp_ge_u32 s2, 256
    s_cbranch_scc1 m_kernel_end
    s_load_dwordx2 s[56:57], s[0:1], 0
    s_load_dwordx2 s[8:9], s[0:1], 8
    s_load_dwordx2 s[10:11], s[0:1], 32
    s_load_dwordx2 s[6:7], s[0:1], 80
    s_load_dwordx2 s[14:15], s[0:1], 48
    s_load_dwordx2 s[12:13], s[0:1], 56
    v_lshrrev_b32 v2, 6, v0
    v_and_b32 v1, 63, v0
    s_nop 0
    v_readfirstlane_b32 s3, v2
    s_nop 1
    s_and_b32 s4, s3, 3
    s_and_b32 s40, s2, 7
    s_lshr_b32 s41, s2, 3
    s_and_b32 s42, s40, 1
    s_lshr_b32 s43, s40, 1
    s_and_b32 s44, s41, 7
    s_lshr_b32 s45, s41, 3
    s_mul_i32 s42, s42, 8
    s_add_u32 s36, s42, s44
    s_mul_i32 s43, s43, 4
    s_add_u32 s37, s43, s45
    s_lshl_b32 s38, s36, 7
    s_lshl_b32 s39, s37, 7
    s_mul_i32 s35, s37, 448
    s_lshl2_add_u32 s34, s36, s4
    s_lshl4_add_u32 s34, s34, s37
    s_lshl_b32 s34, s34, 2
    s_add_u32 s34, s34, 0x2700000
    s_cmp_lt_u32 s3, 4
    s_cbranch_scc1 m_kernel_cons
    v_lshrrev_b32 v2, 3, v1
    s_lshl_b32 s40, s4, 3
    s_add_u32 s40, s40, s38
    v_add_u32 v2, s40, v2
    v_mul_u32_u24 v2, 2048, v2
    v_lshrrev_b32 v3, 4, v1
    s_and_b32 s41, s4, 1
    s_lshl_b32 s41, s41, 2
    v_or_b32 v3, s41, v3
    v_and_b32 v4, 7, v1
    v_xor_b32 v3, v3, v4
    v_lshl_add_u32 v8, v3, 4, v2
    v_add_u32 v9, 65536, v8
    v_add_u32 v10, 131072, v8
    v_add_u32 v11, 196608, v8
    v_subrev_u32 v9, 32768, v9
    v_subrev_u32 v10, 32768, v10
    v_subrev_u32 v11, 32768, v11
    v_subrev_u32 v2, 32768, v8
    v_cmp_gt_i32 vcc, 0, v2
    s_nop 1
    v_cndmask_b32 v8, v2, v8, vcc
    v_lshrrev_b32 v2, 3, v1
    s_lshl_b32 s40, s4, 3
    v_add_u32 v2, s40, v2
    v_mul_u32_u24 v2, 6144, v2
    v_bfe_u32 v3, v1, 4, 1
    s_and_b32 s41, s4, 1
    s_lshl_b32 s41, s41, 1
    v_or_b32 v3, s41, v3
    v_lshlrev_b32 v3, 1, v3
    v_and_b32 v4, 7, v1
    v_xor_b32 v3, v3, v4
    v_lshl_add_u32 v2, v3, 4, v2
    v_add_u32 v12, s39, v2
    v_add_u32 v13, 196608, v12
    v_lshrrev_b32 v2, 3, v1
    s_lshl_b32 s40, s4, 3
    v_add_u32 v2, s40, v2
    v_mul_u32_u24 v2, 2048, v2
    v_bfe_u32 v3, v1, 4, 1
    s_and_b32 s41, s4, 1
    s_lshl_b32 s41, s41, 1
    v_or_b32 v3, s41, v3
    v_lshlrev_b32 v3, 1, v3
    v_and_b32 v4, 7, v1
    v_xor_b32 v3, v3, v4
    v_lshl_add_u32 v2, v3, 4, v2
    v_add_u32 v14, s39, v2
    v_add_u32 v15, 65536, v14
    v_bfe_u32 v2, v1, 3, 2
    s_lshl2_add_u32 s40, s4, s38
    s_add_u32 s40, s40, 112
    v_add_u32 v2, s40, v2
    v_mul_u32_u24 v2, 2048, v2
    v_bfe_u32 v3, v1, 4, 1
    s_lshl_b32 s41, s4, 1
    v_or_b32 v3, s41, v3
    v_and_b32 v4, 7, v1
    v_xor_b32 v3, v3, v4
    v_lshl_add_u32 v16, v3, 4, v2
    s_lshl_b32 s40, s4, 9
    s_sub_u32 s53, 16384, s40
    s_mul_i32 s66, s44, 8
    s_lshr_b32 s66, s66, 3
    s_mul_i32 s67, s45, 8
    s_lshr_b32 s67, s67, 2
    s_add_u32 s66, s66, s67
    s_cmp_ge_u32 s66, 8
    s_cselect_b32 s67, 8, 0
    s_sub_u32 s66, s66, s67
    s_mov_b32 s67, 0
    s_mov_b32 s68, 0
    s_mov_b32 s65, s66
    s_lshl_b32 s50, s4, 10
    s_lshl2_add_u32 s72, s2, s4
    s_lshr_b32 s71, s72, 1
    s_lshl_b32 s71, s71, 12
    s_mul_i32 s33, s72, 3072
    s_add_u32 s33, s33, 3145728
    s_lshl_b32 s32, s72, 10
    s_add_u32 s32, s32, 1048576
    s_mul_i32 s72, s72, 7168
    s_mov_b32 s70, s72
    s_mov_b32 s52, -2
    s_waitcnt lgkmcnt(0)
    s_mov_b32 s16, s6
    s_mov_b32 s17, s7
    s_mov_b32 s18, 0x4000000
    s_mov_b32 s19, 0x20000
    s_mov_b32 s58, 4194304
    s_mov_b32 s59, 0x20000
    s_mov_b64 s[28:29], s[8:9]
    v_mov_b32 v200, 0
    v_mov_b32 v248, 0
    v_mov_b32 v249, 0
    s_lshl2_add_u32 s40, s37, s4
    s_lshl1_add_u32 s55, s40, s38
    s_lshl_b32 s40, s55, 11
    v_lshrrev_b32 v19, 5, v1
    v_and_b32 v2, 31, v1
    v_lshlrev_b32 v2, 4, v2
    v_lshl_add_u32 v2, v19, 11, v2
    buffer_load_dwordx4 v[40:43], v2, s[56:59], s40 offen offset:0
    buffer_load_dwordx4 v[44:47], v2, s[56:59], s40 offen offset:512
    buffer_load_dwordx4 v[48:51], v2, s[56:59], s40 offen offset:1024
    buffer_load_dwordx4 v[52:55], v2, s[56:59], s40 offen offset:1536
    s_mov_b32 s40, 0x2705000
    s_load_dword s5, s[6:7], s40
    s_mov_b32 s20, s8
    s_mov_b32 s21, s9
    s_mov_b32 s22, 0x600000
    s_mov_b32 s23, 0x20000
    s_mov_b32 s24, s10
    s_mov_b32 s25, s11
    s_mov_b32 s26, 0x200000
    s_mov_b32 s27, 0x20000
    s_load_dwordx2 s[8:9], s[0:1], 16
    s_load_dwordx2 s[10:11], s[0:1], 40
m_kernel_l1:
    s_cmp_lt_i32 s52, 0
    s_cbranch_scc1 m_kernel_l1b
    s_sub_u32 s40, s52, 3
    s_cmp_lt_u32 s40, 2
    s_cbranch_scc1 m_kernel_l1w
    s_waitcnt vmcnt(13)
m_kernel_l1w:
    s_waitcnt vmcnt(21)
    s_barrier
    s_min_u32 s72, s72, 7339520
    s_load_dword s73, s[12:13], s72 offset:0
    s_load_dword s73, s[12:13], s72 offset:64
    s_load_dword s73, s[12:13], s72 offset:128
    s_load_dword s73, s[12:13], s72 offset:192
    s_load_dword s73, s[12:13], s72 offset:256
    s_load_dword s73, s[12:13], s72 offset:320
    s_load_dword s73, s[12:13], s72 offset:384
    s_load_dword s73, s[12:13], s72 offset:448
    s_add_u32 s72, s72, 512
m_kernel_l1b:
    s_lshl_b32 s60, s65, 7
    s_mul_i32 s61, s65, 393216
    s_add_u32 s62, s61, 2048
    s_add_u32 s63, s61, 4096
    s_lshl_b32 s64, s65, 17
    s_add_u32 m0, s50, 18432
    s_nop 0
    buffer_load_dwordx4 v12, s[20:23], s61 offen  lds
    s_add_u32 m0, s50, 22528
    s_nop 0
    buffer_load_dwordx4 v13, s[20:23], s61 offen  lds
    s_add_u32 m0, s50, 0
    s_nop 0
    buffer_load_dwordx4 v8, s[56:59], s60 offen  lds
    s_add_u32 m0, s50, 26624
    s_nop 0
    buffer_load_dwordx4 v12, s[20:23], s62 offen  lds
    s_add_u32 m0, s50, 30720
    s_nop 0
    buffer_load_dwordx4 v13, s[20:23], s62 offen  lds
    s_add_u32 m0, s50, 4096
    s_nop 0
    buffer_load_dwordx4 v9, s[56:59], s60 offen  lds
    s_add_u32 m0, s50, 34816
    s_nop 0
    buffer_load_dwordx4 v12, s[20:23], s63 offen  lds
    s_add_u32 m0, s50, 38912
    s_nop 0
    buffer_load_dwordx4 v13, s[20:23], s63 offen  lds
    s_add_u32 m0, s50, 8192
    s_nop 0
    buffer_load_dwordx4 v10, s[56:59], s60 offen  lds
    s_add_u32 m0, s50, 43008
    s_nop 0
    buffer_load_dwordx4 v14, s[24:27], s64 offen  lds
    s_add_u32 m0, s50, 47104
    s_nop 0
    buffer_load_dwordx4 v15, s[24:27], s64 offen  lds
    s_add_u32 m0, s50, 12288
    s_nop 0
    buffer_load_dwordx4 v11, s[56:59], s60 offen  lds
    s_add_u32 m0, s50, s53
    s_mov_b64 exec, 0xffffffff
    buffer_load_dwordx4 v16, s[56:59], s60 offen lds
    s_mov_b64 exec, -1
    s_add_u32 s66, s66, 1
    s_cmp_eq_u32 s66, 8
    s_cselect_b32 s66, 0, s66
    s_add_u32 s67, s67, 1
    s_cmp_eq_u32 s67, 8
    s_cselect_b32 s67, 0, s67
    s_cselect_b32 s69, 8, 0
    s_add_u32 s68, s68, s69
    s_add_u32 s65, s68, s66
    s_add_u32 s50, s50, 51200
    s_cmp_ge_u32 s50, 153600
    s_cselect_b32 s51, 153600, 0
    s_sub_u32 s50, s50, s51
    s_cmp_lg_i32 s52, 2
    s_cbranch_scc1 m_kernel_l1e
    s_mov_b32 s44, s14
    s_mov_b32 s45, s15
    s_mov_b32 s46, 0x700000
    s_mov_b32 s47, 0x20000
    v_and_b32 v2, 7, v1
    v_min_u32 v2, 6, v2
    v_lshrrev_b32 v3, 3, v1
    v_mul_u32_u24 v3, 7168, v3
    v_lshl_add_u32 v3, v2, 4, v3
    s_mul_i32 s48, s36, 458752
    s_mul_i32 s49, s4, 112
    s_add_u32 s49, s49, s35
    s_add_u32 s48, s48, s49
    v_lshrrev_b32 v4, 4, v1
    v_lshlrev_b32 v2, 5, v2
    v_lshl_add_u32 v200, v4, 3, v2
    buffer_load_dwordx4 v[160:163], v3, s[44:47], s48 offen
    s_add_u32 s48, s48, 57344
    buffer_load_dwordx4 v[164:167], v3, s[44:47], s48 offen
    s_add_u32 s48, s48, 57344
    buffer_load_dwordx4 v[168:171], v3, s[44:47], s48 offen
    s_add_u32 s48, s48, 57344
    buffer_load_dwordx4 v[172:175], v3, s[44:47], s48 offen
    s_add_u32 s48, s48, 57344
    buffer_load_dwordx4 v[176:179], v3, s[44:47], s48 offen
    s_add_u32 s48, s48, 57344
    buffer_load_dwordx4 v[180:183], v3, s[44:47], s48 offen
    s_add_u32 s48, s48, 57344
    buffer_load_dwordx4 v[184:187], v3, s[44:47], s48 offen
    s_add_u32 s48, s48, 57344
    buffer_load_dwordx4 v[188:191], v3, s[44:47], s48 offen
    s_add_u32 s48, s48, 57344
m_kernel_l1e:
    s_add_u32 s52, s52, 1
    s_cbranch_scc0 m_kernel_l1d
    v_mov_b32 v24, 0
    v_mov_b32 v25, 0
    v_mov_b32 v26, 0
    v_mov_b32 v27, 0
    s_mov_b32 s54, 0x3f803f80
    s_lshl_b32 s40, s55, 4
    s_add_u32 s40, s40, 0x26c0000
    v_lshlrev_b32 v19, 4, v19
    s_waitcnt vmcnt(26) lgkmcnt(0)
    s_mul_i32 s5, s5, 0x9e3779b1
    s_add_u32 s5, s5, 0x7f4a7c15
    v_dot2c_f32_bf16 v24, s54, v40
    v_dot2c_f32_bf16 v25, v40, v40
    v_dot2c_f32_bf16 v26, s54, v41
    v_dot2c_f32_bf16 v27, v41, v41
    v_dot2c_f32_bf16 v24, s54, v42
    v_dot2c_f32_bf16 v25, v42, v42
    v_dot2c_f32_bf16 v26, s54, v43
    v_dot2c_f32_bf16 v27, v43, v43
    v_dot2c_f32_bf16 v24, s54, v44
    v_dot2c_f32_bf16 v25, v44, v44
    v_dot2c_f32_bf16 v26, s54, v45
    v_dot2c_f32_bf16 v27, v45, v45
    v_dot2c_f32_bf16 v24, s54, v46
    v_dot2c_f32_bf16 v25, v46, v46
    v_dot2c_f32_bf16 v26, s54, v47
    v_dot2c_f32_bf16 v27, v47, v47
    v_dot2c_f32_bf16 v24, s54, v48
    v_dot2c_f32_bf16 v25, v48, v48
    v_dot2c_f32_bf16 v26, s54, v49
    v_dot2c_f32_bf16 v27, v49, v49
    v_dot2c_f32_bf16 v24, s54, v50
    v_dot2c_f32_bf16 v25, v50, v50
    v_dot2c_f32_bf16 v26, s54, v51
    v_dot2c_f32_bf16 v27, v51, v51
    v_dot2c_f32_bf16 v24, s54, v52
    v_dot2c_f32_bf16 v25, v52, v52
    v_dot2c_f32_bf16 v26, s54, v53
    v_dot2c_f32_bf16 v27, v53, v53
    v_dot2c_f32_bf16 v24, s54, v54
    v_dot2c_f32_bf16 v25, v54, v54
    v_dot2c_f32_bf16 v26, s54, v55
    v_dot2c_f32_bf16 v27, v55, v55
    s_nop 2
    v_pk_add_f32 v[24:25], v[24:25], v[26:27]
    s_nop 1
    v_add_f32_dpp v24, v24, v24 quad_perm:[1,0,3,2] row_mask:0xf bank_mask:0xf
    v_add_f32_dpp v25, v25, v25 quad_perm:[1,0,3,2] row_mask:0xf bank_mask:0xf
    s_nop 1
    v_add_f32_dpp v24, v24, v24 quad_perm:[2,3,0,1] row_mask:0xf bank_mask:0xf
    v_add_f32_dpp v25, v25, v25 quad_perm:[2,3,0,1] row_mask:0xf bank_mask:0xf
    s_nop 1
    v_add_f32_dpp v24, v24, v24 row_half_mirror row_mask:0xf bank_mask:0xf
    v_add_f32_dpp v25, v25, v25 row_half_mirror row_mask:0xf bank_mask:0xf
    s_nop 1
    v_add_f32_dpp v24, v24, v24 row_mirror row_mask:0xf bank_mask:0xf
    v_add_f32_dpp v25, v25, v25 row_mirror row_mask:0xf bank_mask:0xf
    v_mov_b32 v26, v24
    v_mov_b32 v27, v25
    s_nop 1
    v_permlane16_swap_b32 v24, v26
    v_permlane16_swap_b32 v25, v27
    s_nop 1
    v_pk_add_f32 v[24:25], v[24:25], v[26:27]
    v_mul_f32 v24, 0xba800000, v24
    v_mul_f32 v25, 0x3a800000, v25
    v_fma_f32 v26, -v24, v24, v25
    v_max_f32 v26, 0, v26
    v_add_f32 v25, 0x3727c5ac, v26
    v_rsq_f32 v25, v25
    v_mov_b32 v27, s5
    v_mul_f32 v26, v26, v25
    v_mul_f32 v26, v26, v25
    v_add_f32 v26, 0x3727c5ac, v26
    v_rsq_f32 v26, v26
    s_mov_b32 exec_lo, 1
    s_mov_b32 exec_hi, 1
    v_mul_f32 v26, v26, v25
    buffer_store_dwordx4 v[24:27], v19, s[16:19], s40 offen sc1
    s_mov_b64 exec, -1
    s_bitcmp1_b32 s4, 0
    s_cselect_b32 s28, s8, s10
    s_cselect_b32 s29, s9, s11
m_kernel_l1d:
    s_cmp_lt_i32 s52, 14
    s_cbranch_scc1 m_kernel_l1
m_kernel_pad0:
    s_cbranch_execz m_kernel_pad1
    s_lshl_b32 s40, s4, 6
    v_add_u32 v2, s40, v1
    v_min_u32 v2, 143, v2
    v_lshlrev_b32 v19, 4, v2
    s_lshl_b32 s40, s38, 4
    v_add_u32 v2, s40, v19
    v_subrev_u32 v3, 256, v2
    v_cmp_gt_i32 vcc, 0, v3
    v_add_u32 v19, 155648, v19
    s_mov_b32 s55, 0x26c0000
    v_cndmask_b32 v18, v3, v2, vcc
    buffer_load_dwordx4 v[24:27], v18, s[16:19], s55 offen sc1
    s_waitcnt lgkmcnt(0)
    s_bitcmp1_b32 s4, 0
    s_cselect_b32 s28, s8, s10
    s_cselect_b32 s29, s9, s11
    s_mov_b32 s30, 2097152
    s_mov_b32 s31, 0x20000
    s_lshl_b32 s40, s2, 13
    s_lshr_b32 s41, s4, 1
    s_lshl_b32 s41, s41, 6
    s_add_u32 s40, s40, s41
    v_lshlrev_b32 v2, 7, v1
    buffer_load_dword v120, v2, s[28:31], s40 offen
    s_waitcnt vmcnt(15)
    s_barrier
    v_mov_b32 v132, v14
    v_mov_b32 v133, v15
    s_lshl_b32 s40, s4, 10
    v_lshl_add_u32 v128, v1, 4, s40
    v_and_b32 v2, 32, v1
    v_and_b32 v3, 1, v1
    v_lshl_add_u32 v2, v3, 4, v2
    v_bfe_u32 v3, v1, 1, 4
    v_add_u32 v2, v2, v3
    v_lshl_add_u32 v136, v2, 4, s40
    s_lshr_b32 s40, s4, 1
    s_mul_i32 s40, s40, 32896
    s_and_b32 s41, s4, 1
    s_lshl_b32 s41, s41, 6
    s_add_u32 s41, s41, s38
    s_lshl4_add_u32 s40, s41, s40
    v_lshl_add_u32 v124, v1, 4, s40
    v_add_u32 v129, 4096, v128
    v_add_u32 v137, 4096, v136
    v_add_u32 v125, 65792, v124
    v_add_u32 v130, 8192, v128
    v_add_u32 v138, 8192, v136
    v_add_u32 v126, 131584, v124
    v_add_u32 v131, 12288, v128
    v_add_u32 v139, 12288, v136
    v_add_u32 v127, 197376, v124
    s_waitcnt vmcnt(1) lgkmcnt(0)
    s_barrier
    s_movk_i32 s41, 0x4000
m_kernel_ss:
    v_cmp_ne_u32 vcc, s5, v27
    s_nop 1
    s_cmp_eq_u64 vcc, 0
    s_cbranch_scc1 m_kernel_ssd
    buffer_load_dwordx4 v[24:27], v18, s[16:19], s55 offen sc1
    s_waitcnt vmcnt(0)
    s_sub_u32 s41, s41, 1
    s_cbranch_scc0 m_kernel_ss
m_kernel_ssd:
    ds_write_b128 v19, v[24:27]
    s_waitcnt lgkmcnt(0)
    s_barrier
    v_and_b32 v4, 31, v1
    s_lshl_b32 s44, s4, 5
    v_add_u32 v4, s44, v4
    v_lshrrev_b32 v5, 5, v1
    v_mul_u32_u24 v8, 144, v4
    v_lshl_add_u32 v8, v5, 4, v8
    v_add_u32 v4, s38, v4
    v_mul_u32_u24 v5, 32896, v5
    v_lshl_add_u32 v9, v4, 4, v5
    s_mul_i32 s44, s37, 263168
    s_add_u32 s44, s44, 0x480000
    s_lshl2_add_u32 s40, s36, s4
    s_add_u32 s41, s40, 1
    s_and_b32 s41, s41, 62
    s_cbranch_scc1 m_kernel_nz
    s_cmp_eq_u32 s40, 0
    s_cselect_b32 s40, 64, 32896
    s_add_u32 s40, s40, s44
    v_bfe_u32 v2, v1, 2, 3
    v_mul_u32_u24 v2, 32896, v2
    v_and_b32 v3, 3, v1
    v_lshl_add_u32 v2, v3, 4, v2
    v_mov_b32 v156, 0
    v_mov_b32 v157, 0
    v_mov_b32 v158, 0
    v_mov_b32 v159, 0
    s_mov_b64 exec, 0xffffffff
    buffer_store_dwordx4 v[156:159], v2, s[16:19], s40 offen sc1
    s_mov_b64 exec, -1
m_kernel_nz:
    s_barrier
    ds_read_b128 v[140:143], v8 offset:59904
    ds_read_b128 v[144:147], v8 offset:59936
    ds_read_b128 v[148:151], v8 offset:59968
    ds_read_b128 v[152:155], v8 offset:60000
    s_waitcnt lgkmcnt(3)
    buffer_store_dwordx4 v[140:143], v9, s[16:19], s44 offen offset:128 sc1
    s_add_u32 s44, s44, 65792
    s_waitcnt lgkmcnt(2)
    buffer_store_dwordx4 v[144:147], v9, s[16:19], s44 offen offset:128 sc1
    s_add_u32 s44, s44, 65792
    s_waitcnt lgkmcnt(1)
    buffer_store_dwordx4 v[148:151], v9, s[16:19], s44 offen offset:128 sc1
    s_add_u32 s44, s44, 65792
    s_waitcnt lgkmcnt(0)
    buffer_store_dwordx4 v[152:155], v9, s[16:19], s44 offen offset:128 sc1
    s_add_u32 s44, s44, 65792
    s_mov_b32 s70, 0x3f80
    s_mov_b32 s71, 0x3f800000
    s_mul_i32 s40, s36, 14336
    s_lshl1_add_u32 s40, s49, s40
    s_add_u32 s40, s40, 0x2600000
    v_mov_b32 v192, 0
    v_mov_b32 v193, 0
    v_mov_b32 v194, 0
    v_mov_b32 v195, 0
    v_mov_b32 v196, 0
    v_mov_b32 v197, 0
    v_mov_b32 v198, 0
    v_mov_b32 v199, 0
    v_dot2c_f32_bf16 v192, s70, v160
    v_dot2c_f32_bf16 v193, s71, v160
    v_dot2c_f32_bf16 v194, s70, v161
    v_dot2c_f32_bf16 v195, s71, v161
    v_dot2c_f32_bf16 v196, s70, v162
    v_dot2c_f32_bf16 v197, s71, v162
    v_dot2c_f32_bf16 v198, s70, v163
    v_dot2c_f32_bf16 v199, s71, v163
    v_dot2c_f32_bf16 v192, s70, v164
    v_dot2c_f32_bf16 v193, s71, v164
    v_dot2c_f32_bf16 v194, s70, v165
    v_dot2c_f32_bf16 v195, s71, v165
    v_dot2c_f32_bf16 v196, s70, v166
    v_dot2c_f32_bf16 v197, s71, v166
    v_dot2c_f32_bf16 v198, s70, v167
    v_dot2c_f32_bf16 v199, s71, v167
    v_dot2c_f32_bf16 v192, s70, v168
    v_dot2c_f32_bf16 v193, s71, v168
    v_dot2c_f32_bf16 v194, s70, v169
    v_dot2c_f32_bf16 v195, s71, v169
    v_dot2c_f32_bf16 v196, s70, v170
    v_dot2c_f32_bf16 v197, s71, v170
    v_dot2c_f32_bf16 v198, s70, v171
    v_dot2c_f32_bf16 v199, s71, v171
    v_dot2c_f32_bf16 v192, s70, v172
    v_dot2c_f32_bf16 v193, s71, v172
    v_dot2c_f32_bf16 v194, s70, v173
    v_dot2c_f32_bf16 v195, s71, v173
    v_dot2c_f32_bf16 v196, s70, v174
    v_dot2c_f32_bf16 v197, s71, v174
    v_dot2c_f32_bf16 v198, s70, v175
    v_dot2c_f32_bf16 v199, s71, v175
    v_dot2c_f32_bf16 v192, s70, v176
    v_dot2c_f32_bf16 v193, s71, v176
    v_dot2c_f32_bf16 v194, s70, v177
    v_dot2c_f32_bf16 v195, s71, v177
    v_dot2c_f32_bf16 v196, s70, v178
    v_dot2c_f32_bf16 v197, s71, v178
    v_dot2c_f32_bf16 v198, s70, v179
    v_dot2c_f32_bf16 v199, s71, v179
    v_dot2c_f32_bf16 v192, s70, v180
    v_dot2c_f32_bf16 v193, s71, v180
    v_dot2c_f32_bf16 v194, s70, v181
    v_dot2c_f32_bf16 v195, s71, v181
    v_dot2c_f32_bf16 v196, s70, v182
    v_dot2c_f32_bf16 v197, s71, v182
    v_dot2c_f32_bf16 v198, s70, v183
    v_dot2c_f32_bf16 v199, s71, v183
    v_dot2c_f32_bf16 v192, s70, v184
    v_dot2c_f32_bf16 v193, s71, v184
    v_dot2c_f32_bf16 v194, s70, v185
    v_dot2c_f32_bf16 v195, s71, v185
    v_dot2c_f32_bf16 v196, s70, v186
    v_dot2c_f32_bf16 v197, s71, v186
    v_dot2c_f32_bf16 v198, s70, v187
    v_dot2c_f32_bf16 v199, s71, v187
    v_dot2c_f32_bf16 v192, s70, v188
    v_dot2c_f32_bf16 v193, s71, v188
    v_dot2c_f32_bf16 v194, s70, v189
    v_dot2c_f32_bf16 v195, s71, v189
    v_dot2c_f32_bf16 v196, s70, v190
    v_dot2c_f32_bf16 v197, s71, v190
    v_dot2c_f32_bf16 v198, s70, v191
    v_dot2c_f32_bf16 v199, s71, v191
    s_nop 2
    v_permlane32_swap_b32 v192, v196
    v_permlane32_swap_b32 v193, v197
    v_permlane32_swap_b32 v194, v198
    v_permlane32_swap_b32 v195, v199
    s_nop 1
    v_pk_add_f32 v[192:193], v[192:193], v[196:197]
    v_pk_add_f32 v[194:195], v[194:195], v[198:199]
    s_nop 1
    v_permlane16_swap_b32 v192, v194
    v_permlane16_swap_b32 v193, v195
    s_nop 1
    v_pk_add_f32 v[192:193], v[192:193], v[194:195]
    s_nop 1
    v_add_f32_dpp v192, v192, v192 row_ror:8 row_mask:0xf bank_mask:0xf
    v_add_f32_dpp v193, v193, v193 row_ror:8 row_mask:0xf bank_mask:0xf
    buffer_store_dwordx2 v[192:193], v200, s[16:19], s40 offen sc1
    s_branch m_kernel_attn
m_kernel_cons:
    v_mov_b32 v16, 0x3f803f80
    v_mov_b32 v68, 0x3f803f80
    v_mov_b32 v17, 0x3f803f80
    v_mov_b32 v69, 0x3f803f80
    v_mov_b32 v18, 0x3f803f80
    v_mov_b32 v70, 0x3f803f80
    v_mov_b32 v19, 0x3f803f80
    v_mov_b32 v71, 0x3f803f80
    v_and_b32 v2, 15, v1
    v_lshrrev_b32 v3, 4, v1
    v_lshrrev_b32 v4, 1, v2
    v_xor_b32 v3, v3, v4
    v_lshlrev_b32 v2, 7, v2
    v_lshl_add_u32 v6, v3, 4, v2
    v_xor_b32 v7, 64, v6
    v_lshrrev_b32 v2, 4, v1
    v_bfe_u32 v3, v1, 2, 2
    v_lshl_add_u32 v4, v2, 3, v3
    v_lshlrev_b32 v4, 7, v4
    v_bfe_u32 v5, v1, 3, 2
    v_xor_b32 v5, s4, v5
    v_lshl_add_u32 v4, v5, 5, v4
    v_and_b32 v3, 3, v1
    v_lshl_add_u32 v4, v3, 3, v4
    v_add_u32 v0, 18432, v4
    s_waitcnt lgkmcnt(0)
    s_mov_b32 s16, s6
    s_mov_b32 s17, s7
    s_mov_b32 s18, 0x4000000
    s_mov_b32 s19, 0x20000
    s_mov_b32 s58, 4194304
    s_mov_b32 s59, 0x20000
    s_mov_b64 s[28:29], s[8:9]
    v_mov_b32 v200, 0
    v_mov_b32 v248, 0
    v_mov_b32 v249, 0
    s_bitcmp1_b32 s4, 0
    s_cselect_b32 s28, s10, s8
    s_cselect_b32 s29, s11, s9
    s_cselect_b32 s40, 4, 12
    s_lshl_b32 s30, s40, 19
    s_mov_b32 s31, 0x20000
    s_add_u32 s41, s2, 256
    s_mul_i32 s41, s41, s40
    s_lshl_b32 s41, s41, 10
    s_sub_u32 s42, 384, s28
    s_and_b32 s42, s42, 0x380
    s_add_u32 s41, s41, s42
    s_sub_u32 s40, s40, 1
    v_lshrrev_b32 v2, 1, v1
    v_min_u32 v2, s40, v2
    v_and_b32 v3, 1, v1
    v_lshlrev_b32 v3, 6, v3
    v_lshl_add_u32 v2, v2, 10, v3
    buffer_load_dword v20, v2, s[28:31], s41 offen
    s_load_dwordx2 s[10:11], s[0:1], 64
    s_mov_b32 s40, 0x2705000
    s_load_dword s5, s[6:7], s40
    s_mov_b32 s20, s56
    s_mov_b32 s21, s57
    s_mov_b32 s22, 0x400000
    s_mov_b32 s23, 0x20000
    v_mov_b32 v120, 0
    v_mov_b32 v121, 0
    v_mov_b32 v122, 0
    v_mov_b32 v123, 0
    v_mov_b32 v124, 0
    v_mov_b32 v125, 0
    v_mov_b32 v126, 0
    v_mov_b32 v127, 0
    v_mov_b32 v128, 0
    v_mov_b32 v129, 0
    v_mov_b32 v130, 0
    v_mov_b32 v131, 0
    v_mov_b32 v132, 0
    v_mov_b32 v133, 0
    v_mov_b32 v134, 0
    v_mov_b32 v135, 0
    v_mov_b32 v136, 0
    v_mov_b32 v137, 0
    v_mov_b32 v138, 0
    v_mov_b32 v139, 0
    v_mov_b32 v140, 0
    v_mov_b32 v141, 0
    v_mov_b32 v142, 0
    v_mov_b32 v143, 0
    v_mov_b32 v144, 0
    v_mov_b32 v145, 0
    v_mov_b32 v146, 0
    v_mov_b32 v147, 0
    v_mov_b32 v148, 0
    v_mov_b32 v149, 0
    v_mov_b32 v150, 0
    v_mov_b32 v151, 0
    v_mov_b32 v152, 0
    v_mov_b32 v153, 0
    v_mov_b32 v154, 0
    v_mov_b32 v155, 0
    v_mov_b32 v156, 0
    v_mov_b32 v157, 0
    v_mov_b32 v158, 0
    v_mov_b32 v159, 0
    v_mov_b32 v160, 0
    v_mov_b32 v161, 0
    v_mov_b32 v162, 0
    v_mov_b32 v163, 0
    v_mov_b32 v164, 0
    v_mov_b32 v165, 0
    v_mov_b32 v166, 0
    v_mov_b32 v167, 0
    v_mov_b32 v168, 0
    v_mov_b32 v169, 0
    v_mov_b32 v170, 0
    v_mov_b32 v171, 0
    v_mov_b32 v172, 0
    v_mov_b32 v173, 0
    v_mov_b32 v174, 0
    v_mov_b32 v175, 0
    v_mov_b32 v176, 0
    v_mov_b32 v177, 0
    v_mov_b32 v178, 0
    v_mov_b32 v179, 0
    v_mov_b32 v180, 0
    v_mov_b32 v181, 0
    v_mov_b32 v182, 0
    v_mov_b32 v183, 0
    v_mov_b32 v184, 0
    v_mov_b32 v185, 0
    v_mov_b32 v186, 0
    v_mov_b32 v187, 0
    v_mov_b32 v188, 0
    v_mov_b32 v189, 0
    v_mov_b32 v190, 0
    v_mov_b32 v191, 0
    v_mov_b32 v192, 0
    v_mov_b32 v193, 0
    v_mov_b32 v194, 0
    v_mov_b32 v195, 0
    v_mov_b32 v196, 0
    v_mov_b32 v197, 0
    v_mov_b32 v198, 0
    v_mov_b32 v199, 0
    v_mov_b32 v200, 0
    v_mov_b32 v201, 0
    v_mov_b32 v202, 0
    v_mov_b32 v203, 0
    v_mov_b32 v204, 0
    v_mov_b32 v205, 0
    v_mov_b32 v206, 0
    v_mov_b32 v207, 0
    v_mov_b32 v208, 0
    v_mov_b32 v209, 0
    v_mov_b32 v210, 0
    v_mov_b32 v211, 0
    v_mov_b32 v212, 0
    v_mov_b32 v213, 0
    v_mov_b32 v214, 0
    v_mov_b32 v215, 0
    v_mov_b32 v216, 0
    v_mov_b32 v217, 0
    v_mov_b32 v218, 0
    v_mov_b32 v219, 0
    v_mov_b32 v220, 0
    v_mov_b32 v221, 0
    v_mov_b32 v222, 0
    v_mov_b32 v223, 0
    v_mov_b32 v224, 0
    v_mov_b32 v225, 0
    v_mov_b32 v226, 0
    v_mov_b32 v227, 0
    v_mov_b32 v228, 0
    v_mov_b32 v229, 0
    v_mov_b32 v230, 0
    v_mov_b32 v231, 0
    v_mov_b32 v232, 0
    v_mov_b32 v233, 0
    v_mov_b32 v234, 0
    v_mov_b32 v235, 0
    v_mov_b32 v236, 0
    v_mov_b32 v237, 0
    v_mov_b32 v238, 0
    v_mov_b32 v239, 0
    v_mov_b32 v240, 0
    v_mov_b32 v241, 0
    v_mov_b32 v242, 0
    v_mov_b32 v243, 0
    v_mov_b32 v244, 0
    v_mov_b32 v245, 0
    v_mov_b32 v246, 0
    v_mov_b32 v247, 0
    v_mov_b32 v248, 0
    v_mov_b32 v249, 0
    v_mov_b32 v250, 0
    v_mov_b32 v251, 0
    v_mov_b32 v252, 0
    v_mov_b32 v253, 0
    v_mov_b32 v254, 0
    v_mov_b32 v255, 0
    v_mov_b32 v8, 0
    v_mov_b32 v9, 0
    v_mov_b32 v10, 0
    v_mov_b32 v11, 0
    v_mov_b32 v12, 0
    v_mov_b32 v13, 0
    v_mov_b32 v14, 0
    v_mov_b32 v15, 0
    s_mov_b32 s56, 0xfffefffe
    s_mov_b32 s57, s56
    s_mov_b64 exec, 0
    s_lshr_b32 s40, s2, 3
    s_mov_b32 s41, -1
m_kernel_wret:
    s_add_u32 s41, s41, 1
    s_cmp_ge_u32 s41, 1
    s_cbranch_scc1 m_kernel_wend
    s_add_u32 s42, s40, s41
    s_and_b32 s42, s42, 0
    s_lshl2_add_u32 s42, s42, s4
    s_cmp_eq_u32 s42, 0
    s_cbranch_scc1 m_kernel_pad0
    s_cmp_eq_u32 s42, 1
    s_cbranch_scc1 m_kernel_pad3
    s_cmp_eq_u32 s42, 2
    s_cbranch_scc1 m_kernel_pad6
    s_cmp_eq_u32 s42, 3
    s_cbranch_scc1 m_kernel_pad9
    s_branch m_kernel_wret
m_kernel_wend:
    s_mov_b64 exec, -1
    s_waitcnt vmcnt(0) lgkmcnt(0)
    s_mul_i32 s5, s5, 0x9e3779b1
    s_add_u32 s5, s5, 0x7f4a7c15
    s_mov_b32 s52, 0
    s_mov_b32 s50, 0
    s_mov_b32 s53, 51200
    s_barrier
    s_mov_b64 exec, s[56:57]
    ds_read_b128 v[16:19], v6 offset:0
    s_mov_b64 exec, -1
    ds_read_b64_tr_b16 v[52:53], v0 offset:0
    ds_read_b64_tr_b16 v[54:55], v0 offset:512
    ds_read_b64_tr_b16 v[56:57], v0 offset:8192
    ds_read_b64_tr_b16 v[58:59], v0 offset:8704
    ds_read_b64_tr_b16 v[60:61], v0 offset:16384
    ds_read_b64_tr_b16 v[62:63], v0 offset:16896
    ds_read_b64_tr_b16 v[64:65], v0 offset:24576
    ds_read_b64_tr_b16 v[66:67], v0 offset:25088
    ds_read_b128 v[20:23], v6 offset:2048
    ds_read_b128 v[24:27], v6 offset:4096
    ds_read_b128 v[28:31], v6 offset:6144
    ds_read_b128 v[32:35], v6 offset:8192
    ds_read_b128 v[36:39], v6 offset:10240
    ds_read_b128 v[40:43], v6 offset:12288
    ds_read_b128 v[44:47], v6 offset:14336
    ds_read_b128 v[48:51], v6 offset:16384
    .p2align 4
m_kernel_c1:
    s_waitcnt lgkmcnt(0)
    v_mfma_f32_16x16x32_bf16 v[8:11], v[52:55], v[16:19], v[8:11]
    s_mov_b64 exec, s[56:57]
    ds_read_b128 v[68:71], v7 offset:0
    s_mov_b64 exec, -1
    v_mfma_f32_16x16x32_bf16 v[248:251], v[56:59], v[16:19], v[248:251]
    ds_read_b64_tr_b16 v[104:105], v0 offset:4096
    v_mfma_f32_16x16x32_bf16 v[252:255], v[60:63], v[16:19], v[252:255]
    ds_read_b64_tr_b16 v[106:107], v0 offset:4608
    v_mfma_f32_16x16x32_bf16 v[12:15], v[64:67], v[16:19], v[12:15]
    ds_read_b64_tr_b16 v[108:109], v0 offset:12288
    v_mfma_f32_16x16x32_bf16 v[120:123], v[52:55], v[20:23], v[120:123]
    ds_read_b64_tr_b16 v[110:111], v0 offset:12800
    v_mfma_f32_16x16x32_bf16 v[124:127], v[56:59], v[20:23], v[124:127]
    ds_read_b64_tr_b16 v[112:113], v0 offset:20480
    v_mfma_f32_16x16x32_bf16 v[128:131], v[60:63], v[20:23], v[128:131]
    ds_read_b64_tr_b16 v[114:115], v0 offset:20992
    v_mfma_f32_16x16x32_bf16 v[132:135], v[64:67], v[20:23], v[132:135]
    ds_read_b64_tr_b16 v[116:117], v0 offset:28672
    v_mfma_f32_16x16x32_bf16 v[136:139], v[52:55], v[24:27], v[136:139]
    ds_read_b64_tr_b16 v[118:119], v0 offset:29184
    v_mfma_f32_16x16x32_bf16 v[140:143], v[56:59], v[24:27], v[140:143]
    ds_read_b128 v[72:75], v7 offset:2048
    v_mfma_f32_16x16x32_bf16 v[144:147], v[60:63], v[24:27], v[144:147]
    ds_read_b128 v[76:79], v7 offset:4096
    v_mfma_f32_16x16x32_bf16 v[148:151], v[64:67], v[24:27], v[148:151]
    ds_read_b128 v[80:83], v7 offset:6144
    v_mfma_f32_16x16x32_bf16 v[152:155], v[52:55], v[28:31], v[152:155]
    ds_read_b128 v[84:87], v7 offset:8192
    v_mfma_f32_16x16x32_bf16 v[156:159], v[56:59], v[28:31], v[156:159]
    ds_read_b128 v[88:91], v7 offset:10240
    v_mfma_f32_16x16x32_bf16 v[160:163], v[60:63], v[28:31], v[160:163]
    ds_read_b128 v[92:95], v7 offset:12288
    v_mfma_f32_16x16x32_bf16 v[164:167], v[64:67], v[28:31], v[164:167]
    ds_read_b128 v[96:99], v7 offset:14336
    v_mfma_f32_16x16x32_bf16 v[168:171], v[52:55], v[32:35], v[168:171]
    ds_read_b128 v[100:103], v7 offset:16384
    v_mfma_f32_16x16x32_bf16 v[172:175], v[56:59], v[32:35], v[172:175]
    s_add_u32 s50, s50, 51200
    s_cmp_ge_u32 s50, 153600
    v_mfma_f32_16x16x32_bf16 v[176:179], v[60:63], v[32:35], v[176:179]
    s_cselect_b32 s51, 0xfffe7000, s53
    s_cselect_b32 s50, 0, s50
    v_mfma_f32_16x16x32_bf16 v[180:183], v[64:67], v[32:35], v[180:183]
    v_add_u32 v6, s51, v6
    v_mfma_f32_16x16x32_bf16 v[184:187], v[52:55], v[36:39], v[184:187]
    v_mfma_f32_16x16x32_bf16 v[188:191], v[56:59], v[36:39], v[188:191]
    v_mfma_f32_16x16x32_bf16 v[192:195], v[60:63], v[36:39], v[192:195]
    v_mfma_f32_16x16x32_bf16 v[196:199], v[64:67], v[36:39], v[196:199]
    v_mfma_f32_16x16x32_bf16 v[200:203], v[52:55], v[40:43], v[200:203]
    v_mfma_f32_16x16x32_bf16 v[204:207], v[56:59], v[40:43], v[204:207]
    v_mfma_f32_16x16x32_bf16 v[208:211], v[60:63], v[40:43], v[208:211]
    v_mfma_f32_16x16x32_bf16 v[212:215], v[64:67], v[40:43], v[212:215]
    v_mfma_f32_16x16x32_bf16 v[216:219], v[52:55], v[44:47], v[216:219]
    v_mfma_f32_16x16x32_bf16 v[220:223], v[56:59], v[44:47], v[220:223]
    v_mfma_f32_16x16x32_bf16 v[224:227], v[60:63], v[44:47], v[224:227]
    v_mfma_f32_16x16x32_bf16 v[228:231], v[64:67], v[44:47], v[228:231]
    v_mfma_f32_16x16x32_bf16 v[232:235], v[52:55], v[48:51], v[232:235]
    v_mfma_f32_16x16x32_bf16 v[236:239], v[56:59], v[48:51], v[236:239]
    v_mfma_f32_16x16x32_bf16 v[240:243], v[60:63], v[48:51], v[240:243]
    v_mfma_f32_16x16x32_bf16 v[244:247], v[64:67], v[48:51], v[244:247]
    s_waitcnt lgkmcnt(0)
    v_mfma_f32_16x16x32_bf16 v[8:11], v[104:107], v[68:71], v[8:11]
    s_barrier
    v_add_u32 v0, s51, v0
    v_mfma_f32_16x16x32_bf16 v[248:251], v[108:111], v[68:71], v[248:251]
    s_mov_b64 exec, s[56:57]
    ds_read_b128 v[16:19], v6 offset:0
    s_mov_b64 exec, -1
    v_mfma_f32_16x16x32_bf16 v[252:255], v[112:115], v[68:71], v[252:255]
    ds_read_b64_tr_b16 v[52:53], v0 offset:0
    v_mfma_f32_16x16x32_bf16 v[12:15], v[116:119], v[68:71], v[12:15]
    ds_read_b64_tr_b16 v[54:55], v0 offset:512
    v_mfma_f32_16x16x32_bf16 v[120:123], v[104:107], v[72:75], v[120:123]
    ds_read_b64_tr_b16 v[56:57], v0 offset:8192
    v_mfma_f32_16x16x32_bf16 v[124:127], v[108:111], v[72:75], v[124:127]
    ds_read_b64_tr_b16 v[58:59], v0 offset:8704
    v_mfma_f32_16x16x32_bf16 v[128:131], v[112:115], v[72:75], v[128:131]
    ds_read_b64_tr_b16 v[60:61], v0 offset:16384
    v_mfma_f32_16x16x32_bf16 v[132:135], v[116:119], v[72:75], v[132:135]
    ds_read_b64_tr_b16 v[62:63], v0 offset:16896
    v_mfma_f32_16x16x32_bf16 v[136:139], v[104:107], v[76:79], v[136:139]
    ds_read_b64_tr_b16 v[64:65], v0 offset:24576
    v_mfma_f32_16x16x32_bf16 v[140:143], v[108:111], v[76:79], v[140:143]
    ds_read_b64_tr_b16 v[66:67], v0 offset:25088
    v_mfma_f32_16x16x32_bf16 v[144:147], v[112:115], v[76:79], v[144:147]
    ds_read_b128 v[20:23], v6 offset:2048
    v_mfma_f32_16x16x32_bf16 v[148:151], v[116:119], v[76:79], v[148:151]
    ds_read_b128 v[24:27], v6 offset:4096
    v_mfma_f32_16x16x32_bf16 v[152:155], v[104:107], v[80:83], v[152:155]
    ds_read_b128 v[28:31], v6 offset:6144
    v_mfma_f32_16x16x32_bf16 v[156:159], v[108:111], v[80:83], v[156:159]
    ds_read_b128 v[32:35], v6 offset:8192
    v_mfma_f32_16x16x32_bf16 v[160:163], v[112:115], v[80:83], v[160:163]
    ds_read_b128 v[36:39], v6 offset:10240
    v_mfma_f32_16x16x32_bf16 v[164:167], v[116:119], v[80:83], v[164:167]
    ds_read_b128 v[40:43], v6 offset:12288
    v_mfma_f32_16x16x32_bf16 v[168:171], v[104:107], v[84:87], v[168:171]
    ds_read_b128 v[44:47], v6 offset:14336
    v_mfma_f32_16x16x32_bf16 v[172:175], v[108:111], v[84:87], v[172:175]
    ds_read_b128 v[48:51], v6 offset:16384
    v_mfma_f32_16x16x32_bf16 v[176:179], v[112:115], v[84:87], v[176:179]
    v_add_u32 v7, s51, v7
    v_mfma_f32_16x16x32_bf16 v[180:183], v[116:119], v[84:87], v[180:183]
    s_add_u32 s52, s52, 1
    v_mfma_f32_16x16x32_bf16 v[184:187], v[104:107], v[88:91], v[184:187]
    s_cmp_lt_u32 s52, 16
    v_mfma_f32_16x16x32_bf16 v[188:191], v[108:111], v[88:91], v[188:191]
    v_mfma_f32_16x16x32_bf16 v[192:195], v[112:115], v[88:91], v[192:195]
    v_mfma_f32_16x16x32_bf16 v[196:199], v[116:119], v[88:91], v[196:199]
    v_mfma_f32_16x16x32_bf16 v[200:203], v[104:107], v[92:95], v[200:203]
    v_mfma_f32_16x16x32_bf16 v[204:207], v[108:111], v[92:95], v[204:207]
    v_mfma_f32_16x16x32_bf16 v[208:211], v[112:115], v[92:95], v[208:211]
    v_mfma_f32_16x16x32_bf16 v[212:215], v[116:119], v[92:95], v[212:215]
    v_mfma_f32_16x16x32_bf16 v[216:219], v[104:107], v[96:99], v[216:219]
    v_mfma_f32_16x16x32_bf16 v[220:223], v[108:111], v[96:99], v[220:223]
    v_mfma_f32_16x16x32_bf16 v[224:227], v[112:115], v[96:99], v[224:227]
    v_mfma_f32_16x16x32_bf16 v[228:231], v[116:119], v[96:99], v[228:231]
    v_mfma_f32_16x16x32_bf16 v[232:235], v[104:107], v[100:103], v[232:235]
    v_mfma_f32_16x16x32_bf16 v[236:239], v[108:111], v[100:103], v[236:239]
    v_mfma_f32_16x16x32_bf16 v[240:243], v[112:115], v[100:103], v[240:243]
    v_mfma_f32_16x16x32_bf16 v[244:247], v[116:119], v[100:103], v[244:247]
    s_cbranch_scc1 m_kernel_c1
m_kernel_pad1:
    s_cbranch_execz m_kernel_pad2
    v_and_b32 v2, 15, v1
    v_lshlrev_b32 v2, 4, v2
    v_add_u32 v2, 155648, v2
    s_waitcnt lgkmcnt(0)
    ds_read_b128 v[20:23], v2 offset:256
    ds_read_b128 v[24:27], v2 offset:512
    ds_read_b128 v[28:31], v2 offset:768
    ds_read_b128 v[32:35], v2 offset:1024
    ds_read_b128 v[36:39], v2 offset:1280
    ds_read_b128 v[40:43], v2 offset:1536
    ds_read_b128 v[44:47], v2 offset:1792
    ds_read_b128 v[48:51], v2 offset:2048
    ds_read_b128 v[16:19], v2 offset:0
    v_mov_b32_dpp v64, v12 row_newbcast:0 row_mask:0xf bank_mask:0xf
    v_mov_b32_dpp v65, v13 row_newbcast:0 row_mask:0xf bank_mask:0xf
    v_mov_b32_dpp v66, v14 row_newbcast:0 row_mask:0xf bank_mask:0xf
    v_mov_b32_dpp v67, v15 row_newbcast:0 row_mask:0xf bank_mask:0xf
    v_mov_b32_dpp v52, v8 row_newbcast:0 row_mask:0xf bank_mask:0xf
    v_mov_b32_dpp v53, v9 row_newbcast:0 row_mask:0xf bank_mask:0xf
    v_mov_b32_dpp v54, v10 row_newbcast:0 row_mask:0xf bank_mask:0xf
    v_mov_b32_dpp v55, v11 row_newbcast:0 row_mask:0xf bank_mask:0xf
    v_mov_b32_dpp v56, v248 row_newbcast:0 row_mask:0xf bank_mask:0xf
    v_mov_b32_dpp v57, v249 row_newbcast:0 row_mask:0xf bank_mask:0xf
    v_mov_b32_dpp v58, v250 row_newbcast:0 row_mask:0xf bank_mask:0xf
    v_mov_b32_dpp v59, v251 row_newbcast:0 row_mask:0xf bank_mask:0xf
    v_mov_b32_dpp v60, v252 row_newbcast:0 row_mask:0xf bank_mask:0xf
    v_mov_b32_dpp v61, v253 row_newbcast:0 row_mask:0xf bank_mask:0xf
    v_mov_b32_dpp v62, v254 row_newbcast:0 row_mask:0xf bank_mask:0xf
    v_mov_b32_dpp v63, v255 row_newbcast:0 row_mask:0xf bank_mask:0xf
    s_mov_b32 s70, 0xbdd2d3e8
    s_mov_b32 s71, s70
    v_mov_b32 v4, 0xc0135761
    v_mov_b32 v5, v4
    v_and_b32 v2, 15, v1
    v_mul_u32_u24 v2, 144, v2
    v_lshrrev_b32 v3, 4, v1
    v_lshl_add_u32 v2, v3, 3, v2
    s_lshl_b32 s40, s4, 5
    v_add_u32 v2, s40, v2
    v_add_u32 v3, 39168, v2
    s_waitcnt lgkmcnt(0)
    v_pk_fma_f32 v[132:133], v[64:65], v[20:21], v[132:133] op_sel_hi:[1,0,1]
    v_pk_fma_f32 v[134:135], v[66:67], v[20:21], v[134:135] op_sel_hi:[1,0,1]
    v_pk_mul_f32 v[132:133], v[132:133], v[22:23] op_sel_hi:[1,0]
    v_pk_mul_f32 v[134:135], v[134:135], v[22:23] op_sel_hi:[1,0]
    v_pk_fma_f32 v[148:149], v[64:65], v[24:25], v[148:149] op_sel_hi:[1,0,1]
    v_pk_fma_f32 v[150:151], v[66:67], v[24:25], v[150:151] op_sel_hi:[1,0,1]
    v_pk_mul_f32 v[148:149], v[148:149], v[26:27] op_sel_hi:[1,0]
    v_pk_mul_f32 v[150:151], v[150:151], v[26:27] op_sel_hi:[1,0]
    v_pk_mul_f32 v[72:73], v[132:133], v[132:133]
    v_pk_mul_f32 v[74:75], v[134:135], v[134:135]
    v_pk_mul_f32 v[76:77], v[148:149], v[148:149]
    v_pk_mul_f32 v[78:79], v[150:151], v[150:151]
    v_pk_fma_f32 v[72:73], v[72:73], s[70:71], v[4:5]
    v_pk_fma_f32 v[74:75], v[74:75], s[70:71], v[4:5]
    v_pk_fma_f32 v[76:77], v[76:77], s[70:71], v[4:5]
    v_pk_fma_f32 v[78:79], v[78:79], s[70:71], v[4:5]
    v_pk_mul_f32 v[72:73], v[72:73], v[132:133]
    v_pk_mul_f32 v[74:75], v[74:75], v[134:135]
    v_pk_mul_f32 v[76:77], v[76:77], v[148:149]
    v_pk_mul_f32 v[78:79], v[78:79], v[150:151]
    v_exp_f32 v72, v72
    v_exp_f32 v73, v73
    v_exp_f32 v74, v74
    v_exp_f32 v75, v75
    v_exp_f32 v76, v76
    v_exp_f32 v77, v77
    v_exp_f32 v78, v78
    v_exp_f32 v79, v79
    v_pk_add_f32 v[72:73], v[72:73], 1.0 op_sel_hi:[1,0]
    v_pk_add_f32 v[74:75], v[74:75], 1.0 op_sel_hi:[1,0]
    v_pk_add_f32 v[76:77], v[76:77], 1.0 op_sel_hi:[1,0]
    v_pk_add_f32 v[78:79], v[78:79], 1.0 op_sel_hi:[1,0]
    v_rcp_f32 v72, v72
    v_rcp_f32 v73, v73
    v_rcp_f32 v74, v74
    v_rcp_f32 v75, v75
    v_rcp_f32 v76, v76
    v_rcp_f32 v77, v77
    v_rcp_f32 v78, v78
    v_rcp_f32 v79, v79
    v_pk_mul_f32 v[132:133], v[132:133], v[72:73]
    v_pk_mul_f32 v[134:135], v[134:135], v[74:75]
    v_pk_mul_f32 v[148:149], v[148:149], v[76:77]
    v_pk_mul_f32 v[150:151], v[150:151], v[78:79]
    v_cvt_pk_bf16_f32 v80, v132, v133
    v_cvt_pk_bf16_f32 v81, v134, v135
    v_cvt_pk_bf16_f32 v82, v148, v149
    v_cvt_pk_bf16_f32 v83, v150, v151
    ds_write_b64 v3, v[80:81] offset:20736
    ds_write_b64 v3, v[82:83] offset:23040
    v_pk_fma_f32 v[164:165], v[64:65], v[28:29], v[164:165] op_sel_hi:[1,0,1]
    v_pk_fma_f32 v[166:167], v[66:67], v[28:29], v[166:167] op_sel_hi:[1,0,1]
    v_pk_mul_f32 v[164:165], v[164:165], v[30:31] op_sel_hi:[1,0]
    v_pk_mul_f32 v[166:167], v[166:167], v[30:31] op_sel_hi:[1,0]
    v_pk_fma_f32 v[180:181], v[64:65], v[32:33], v[180:181] op_sel_hi:[1,0,1]
    v_pk_fma_f32 v[182:183], v[66:67], v[32:33], v[182:183] op_sel_hi:[1,0,1]
    v_pk_mul_f32 v[180:181], v[180:181], v[34:35] op_sel_hi:[1,0]
    v_pk_mul_f32 v[182:183], v[182:183], v[34:35] op_sel_hi:[1,0]
    v_pk_mul_f32 v[72:73], v[164:165], v[164:165]
    v_pk_mul_f32 v[74:75], v[166:167], v[166:167]
    v_pk_mul_f32 v[76:77], v[180:181], v[180:181]
    v_pk_mul_f32 v[78:79], v[182:183], v[182:183]
    v_pk_fma_f32 v[72:73], v[72:73], s[70:71], v[4:5]
    v_pk_fma_f32 v[74:75], v[74:75], s[70:71], v[4:5]
    v_pk_fma_f32 v[76:77], v[76:77], s[70:71], v[4:5]
    v_pk_fma_f32 v[78:79], v[78:79], s[70:71], v[4:5]
    v_pk_mul_f32 v[72:73], v[72:73], v[164:165]
    v_pk_mul_f32 v[74:75], v[74:75], v[166:167]
    v_pk_mul_f32 v[76:77], v[76:77], v[180:181]
    v_pk_mul_f32 v[78:79], v[78:79], v[182:183]
    v_exp_f32 v72, v72
    v_exp_f32 v73, v73
    v_exp_f32 v74, v74
    v_exp_f32 v75, v75
    v_exp_f32 v76, v76
    v_exp_f32 v77, v77
    v_exp_f32 v78, v78
    v_exp_f32 v79, v79
    v_pk_add_f32 v[72:73], v[72:73], 1.0 op_sel_hi:[1,0]
    v_pk_add_f32 v[74:75], v[74:75], 1.0 op_sel_hi:[1,0]
    v_pk_add_f32 v[76:77], v[76:77], 1.0 op_sel_hi:[1,0]
    v_pk_add_f32 v[78:79], v[78:79], 1.0 op_sel_hi:[1,0]
    v_rcp_f32 v72, v72
    v_rcp_f32 v73, v73
    v_rcp_f32 v74, v74
    v_rcp_f32 v75, v75
    v_rcp_f32 v76, v76
    v_rcp_f32 v77, v77
    v_rcp_f32 v78, v78
    v_rcp_f32 v79, v79
    v_pk_mul_f32 v[164:165], v[164:165], v[72:73]
    v_pk_mul_f32 v[166:167], v[166:167], v[74:75]
    v_pk_mul_f32 v[180:181], v[180:181], v[76:77]
    v_pk_mul_f32 v[182:183], v[182:183], v[78:79]
    v_cvt_pk_bf16_f32 v84, v164, v165
    v_cvt_pk_bf16_f32 v85, v166, v167
    v_cvt_pk_bf16_f32 v86, v180, v181
    v_cvt_pk_bf16_f32 v87, v182, v183
    ds_write_b64 v3, v[84:85] offset:25344
    ds_write_b64 v3, v[86:87] offset:27648
    v_pk_fma_f32 v[196:197], v[64:65], v[36:37], v[196:197] op_sel_hi:[1,0,1]
    v_pk_fma_f32 v[198:199], v[66:67], v[36:37], v[198:199] op_sel_hi:[1,0,1]
    v_pk_mul_f32 v[196:197], v[196:197], v[38:39] op_sel_hi:[1,0]
    v_pk_mul_f32 v[198:199], v[198:199], v[38:39] op_sel_hi:[1,0]
    v_pk_fma_f32 v[212:213], v[64:65], v[40:41], v[212:213] op_sel_hi:[1,0,1]
    v_pk_fma_f32 v[214:215], v[66:67], v[40:41], v[214:215] op_sel_hi:[1,0,1]
    v_pk_mul_f32 v[212:213], v[212:213], v[42:43] op_sel_hi:[1,0]
    v_pk_mul_f32 v[214:215], v[214:215], v[42:43] op_sel_hi:[1,0]
    v_pk_mul_f32 v[72:73], v[196:197], v[196:197]
    v_pk_mul_f32 v[74:75], v[198:199], v[198:199]
    v_pk_mul_f32 v[76:77], v[212:213], v[212:213]
    v_pk_mul_f32 v[78:79], v[214:215], v[214:215]
    v_pk_fma_f32 v[72:73], v[72:73], s[70:71], v[4:5]
    v_pk_fma_f32 v[74:75], v[74:75], s[70:71], v[4:5]
    v_pk_fma_f32 v[76:77], v[76:77], s[70:71], v[4:5]
    v_pk_fma_f32 v[78:79], v[78:79], s[70:71], v[4:5]
    v_pk_mul_f32 v[72:73], v[72:73], v[196:197]
    v_pk_mul_f32 v[74:75], v[74:75], v[198:199]
    v_pk_mul_f32 v[76:77], v[76:77], v[212:213]
    v_pk_mul_f32 v[78:79], v[78:79], v[214:215]
    v_exp_f32 v72, v72
    v_exp_f32 v73, v73
    v_exp_f32 v74, v74
    v_exp_f32 v75, v75
    v_exp_f32 v76, v76
    v_exp_f32 v77, v77
    v_exp_f32 v78, v78
    v_exp_f32 v79, v79
    v_pk_add_f32 v[72:73], v[72:73], 1.0 op_sel_hi:[1,0]
    v_pk_add_f32 v[74:75], v[74:75], 1.0 op_sel_hi:[1,0]
m_kernel_pad2:
    s_cbranch_execz m_kernel_wret
    v_pk_add_f32 v[76:77], v[76:77], 1.0 op_sel_hi:[1,0]
    v_pk_add_f32 v[78:79], v[78:79], 1.0 op_sel_hi:[1,0]
    v_rcp_f32 v72, v72
    v_rcp_f32 v73, v73
    v_rcp_f32 v74, v74
    v_rcp_f32 v75, v75
    v_rcp_f32 v76, v76
    v_rcp_f32 v77, v77
    v_rcp_f32 v78, v78
    v_rcp_f32 v79, v79
    v_pk_mul_f32 v[196:197], v[196:197], v[72:73]
    v_pk_mul_f32 v[198:199], v[198:199], v[74:75]
    v_pk_mul_f32 v[212:213], v[212:213], v[76:77]
    v_pk_mul_f32 v[214:215], v[214:215], v[78:79]
    v_cvt_pk_bf16_f32 v88, v196, v197
    v_cvt_pk_bf16_f32 v89, v198, v199
    v_cvt_pk_bf16_f32 v90, v212, v213
    v_cvt_pk_bf16_f32 v91, v214, v215
    ds_write_b64 v3, v[88:89] offset:29952
    ds_write_b64 v3, v[90:91] offset:32256
    v_pk_fma_f32 v[228:229], v[64:65], v[44:45], v[228:229] op_sel_hi:[1,0,1]
    v_pk_fma_f32 v[230:231], v[66:67], v[44:45], v[230:231] op_sel_hi:[1,0,1]
    v_pk_mul_f32 v[228:229], v[228:229], v[46:47] op_sel_hi:[1,0]
    v_pk_mul_f32 v[230:231], v[230:231], v[46:47] op_sel_hi:[1,0]
    v_pk_fma_f32 v[244:245], v[64:65], v[48:49], v[244:245] op_sel_hi:[1,0,1]
    v_pk_fma_f32 v[246:247], v[66:67], v[48:49], v[246:247] op_sel_hi:[1,0,1]
    v_pk_mul_f32 v[244:245], v[244:245], v[50:51] op_sel_hi:[1,0]
    v_pk_mul_f32 v[246:247], v[246:247], v[50:51] op_sel_hi:[1,0]
    v_pk_mul_f32 v[72:73], v[228:229], v[228:229]
    v_pk_mul_f32 v[74:75], v[230:231], v[230:231]
    v_pk_mul_f32 v[76:77], v[244:245], v[244:245]
    v_pk_mul_f32 v[78:79], v[246:247], v[246:247]
    v_pk_fma_f32 v[72:73], v[72:73], s[70:71], v[4:5]
    v_pk_fma_f32 v[74:75], v[74:75], s[70:71], v[4:5]
    v_pk_fma_f32 v[76:77], v[76:77], s[70:71], v[4:5]
    v_pk_fma_f32 v[78:79], v[78:79], s[70:71], v[4:5]
    v_pk_mul_f32 v[72:73], v[72:73], v[228:229]
    v_pk_mul_f32 v[74:75], v[74:75], v[230:231]
    v_pk_mul_f32 v[76:77], v[76:77], v[244:245]
    v_pk_mul_f32 v[78:79], v[78:79], v[246:247]
    v_exp_f32 v72, v72
    v_exp_f32 v73, v73
    v_exp_f32 v74, v74
    v_exp_f32 v75, v75
    v_exp_f32 v76, v76
    v_exp_f32 v77, v77
    v_exp_f32 v78, v78
    v_exp_f32 v79, v79
    v_pk_add_f32 v[72:73], v[72:73], 1.0 op_sel_hi:[1,0]
    v_pk_add_f32 v[74:75], v[74:75], 1.0 op_sel_hi:[1,0]
    v_pk_add_f32 v[76:77], v[76:77], 1.0 op_sel_hi:[1,0]
    v_pk_add_f32 v[78:79], v[78:79], 1.0 op_sel_hi:[1,0]
    v_rcp_f32 v72, v72
    v_rcp_f32 v73, v73
    v_rcp_f32 v74, v74
    v_rcp_f32 v75, v75
    v_rcp_f32 v76, v76
    v_rcp_f32 v77, v77
    v_rcp_f32 v78, v78
    v_rcp_f32 v79, v79
    v_pk_mul_f32 v[228:229], v[228:229], v[72:73]
    v_pk_mul_f32 v[230:231], v[230:231], v[74:75]
    v_pk_mul_f32 v[244:245], v[244:245], v[76:77]
    v_pk_mul_f32 v[246:247], v[246:247], v[78:79]
    v_cvt_pk_bf16_f32 v92, v228, v229
    v_cvt_pk_bf16_f32 v93, v230, v231
    v_cvt_pk_bf16_f32 v94, v244, v245
    v_cvt_pk_bf16_f32 v95, v246, v247
    ds_write_b64 v3, v[92:93] offset:34560
    ds_write_b64 v3, v[94:95] offset:36864
    s_waitcnt lgkmcnt(0)
    s_barrier
    v_pk_fma_f32 v[248:249], v[56:57], v[16:17], v[248:249] op_sel_hi:[1,0,1]
    v_pk_fma_f32 v[250:251], v[58:59], v[16:17], v[250:251] op_sel_hi:[1,0,1]
    v_pk_mul_f32 v[248:249], v[248:249], v[16:17] op_sel:[0,1] op_sel_hi:[1,1]
    v_pk_mul_f32 v[250:251], v[250:251], v[16:17] op_sel:[0,1] op_sel_hi:[1,1]
    v_cvt_pk_bf16_f32 v68, v248, v249
    v_cvt_pk_bf16_f32 v69, v250, v251
    ds_write_b64 v2, v[68:69] offset:18432
    v_pk_fma_f32 v[252:253], v[60:61], v[16:17], v[252:253] op_sel_hi:[1,0,1]
    v_pk_fma_f32 v[254:255], v[62:63], v[16:17], v[254:255] op_sel_hi:[1,0,1]
    v_pk_mul_f32 v[252:253], v[252:253], v[16:17] op_sel:[0,1] op_sel_hi:[1,1]
    v_pk_mul_f32 v[254:255], v[254:255], v[16:17] op_sel:[0,1] op_sel_hi:[1,1]
    v_cvt_pk_bf16_f32 v70, v252, v253
    v_cvt_pk_bf16_f32 v71, v254, v255
    ds_write_b64 v3, v[70:71] offset:0
    v_pk_fma_f32 v[120:121], v[52:53], v[20:21], v[120:121] op_sel_hi:[1,0,1]
    v_pk_fma_f32 v[122:123], v[54:55], v[20:21], v[122:123] op_sel_hi:[1,0,1]
    v_pk_mul_f32 v[120:121], v[120:121], v[20:21] op_sel:[0,1] op_sel_hi:[1,1]
    v_pk_mul_f32 v[122:123], v[122:123], v[20:21] op_sel:[0,1] op_sel_hi:[1,1]
    v_cvt_pk_bf16_f32 v72, v120, v121
    v_cvt_pk_bf16_f32 v73, v122, v123
    ds_write_b64 v2, v[72:73] offset:0
    v_pk_fma_f32 v[124:125], v[56:57], v[20:21], v[124:125] op_sel_hi:[1,0,1]
    v_pk_fma_f32 v[126:127], v[58:59], v[20:21], v[126:127] op_sel_hi:[1,0,1]
    v_pk_mul_f32 v[124:125], v[124:125], v[20:21] op_sel:[0,1] op_sel_hi:[1,1]
    v_pk_mul_f32 v[126:127], v[126:127], v[20:21] op_sel:[0,1] op_sel_hi:[1,1]
    v_cvt_pk_bf16_f32 v74, v124, v125
    v_cvt_pk_bf16_f32 v75, v126, v127
    ds_write_b64 v2, v[74:75] offset:20736
    v_pk_fma_f32 v[128:129], v[60:61], v[20:21], v[128:129] op_sel_hi:[1,0,1]
    v_pk_fma_f32 v[130:131], v[62:63], v[20:21], v[130:131] op_sel_hi:[1,0,1]
    v_pk_mul_f32 v[128:129], v[128:129], v[20:21] op_sel:[0,1] op_sel_hi:[1,1]
    v_pk_mul_f32 v[130:131], v[130:131], v[20:21] op_sel:[0,1] op_sel_hi:[1,1]
    v_cvt_pk_bf16_f32 v76, v128, v129
    v_cvt_pk_bf16_f32 v77, v130, v131
    ds_write_b64 v3, v[76:77] offset:2304
    v_pk_fma_f32 v[136:137], v[52:53], v[24:25], v[136:137] op_sel_hi:[1,0,1]
    v_pk_fma_f32 v[138:139], v[54:55], v[24:25], v[138:139] op_sel_hi:[1,0,1]
    v_pk_mul_f32 v[136:137], v[136:137], v[24:25] op_sel:[0,1] op_sel_hi:[1,1]
    v_pk_mul_f32 v[138:139], v[138:139], v[24:25] op_sel:[0,1] op_sel_hi:[1,1]
    v_cvt_pk_bf16_f32 v78, v136, v137
    v_cvt_pk_bf16_f32 v79, v138, v139
    ds_write_b64 v2, v[78:79] offset:2304
    v_pk_fma_f32 v[140:141], v[56:57], v[24:25], v[140:141] op_sel_hi:[1,0,1]
    v_pk_fma_f32 v[142:143], v[58:59], v[24:25], v[142:143] op_sel_hi:[1,0,1]
    v_pk_mul_f32 v[140:141], v[140:141], v[24:25] op_sel:[0,1] op_sel_hi:[1,1]
    v_pk_mul_f32 v[142:143], v[142:143], v[24:25] op_sel:[0,1] op_sel_hi:[1,1]
    v_cvt_pk_bf16_f32 v80, v140, v141
    v_cvt_pk_bf16_f32 v81, v142, v143
    ds_write_b64 v2, v[80:81] offset:23040
    v_pk_fma_f32 v[144:145], v[60:61], v[24:25], v[144:145] op_sel_hi:[1,0,1]
    v_pk_fma_f32 v[146:147], v[62:63], v[24:25], v[146:147] op_sel_hi:[1,0,1]
    v_pk_mul_f32 v[144:145], v[144:145], v[24:25] op_sel:[0,1] op_sel_hi:[1,1]
    v_pk_mul_f32 v[146:147], v[146:147], v[24:25] op_sel:[0,1] op_sel_hi:[1,1]
    v_cvt_pk_bf16_f32 v82, v144, v145
    v_cvt_pk_bf16_f32 v83, v146, v147
    ds_write_b64 v3, v[82:83] offset:4608
    v_pk_fma_f32 v[152:153], v[52:53], v[28:29], v[152:153] op_sel_hi:[1,0,1]
    v_pk_fma_f32 v[154:155], v[54:55], v[28:29], v[154:155] op_sel_hi:[1,0,1]
    v_pk_mul_f32 v[152:153], v[152:153], v[28:29] op_sel:[0,1] op_sel_hi:[1,1]
    v_pk_mul_f32 v[154:155], v[154:155], v[28:29] op_sel:[0,1] op_sel_hi:[1,1]
    v_cvt_pk_bf16_f32 v84, v152, v153
    v_cvt_pk_bf16_f32 v85, v154, v155
    ds_write_b64 v2, v[84:85] offset:4608
    v_pk_fma_f32 v[156:157], v[56:57], v[28:29], v[156:157] op_sel_hi:[1,0,1]
    v_pk_fma_f32 v[158:159], v[58:59], v[28:29], v[158:159] op_sel_hi:[1,0,1]
    v_pk_mul_f32 v[156:157], v[156:157], v[28:29] op_sel:[0,1] op_sel_hi:[1,1]
    v_pk_mul_f32 v[158:159], v[158:159], v[28:29] op_sel:[0,1] op_sel_hi:[1,1]
    v_cvt_pk_bf16_f32 v86, v156, v157
    v_cvt_pk_bf16_f32 v87, v158, v159
    ds_write_b64 v2, v[86:87] offset:25344
    v_pk_fma_f32 v[160:161], v[60:61], v[28:29], v[160:161] op_sel_hi:[1,0,1]
    v_pk_fma_f32 v[162:163], v[62:63], v[28:29], v[162:163] op_sel_hi:[1,0,1]
    v_pk_mul_f32 v[160:161], v[160:161], v[28:29] op_sel:[0,1] op_sel_hi:[1,1]
    v_pk_mul_f32 v[162:163], v[162:163], v[28:29] op_sel:[0,1] op_sel_hi:[1,1]
    v_cvt_pk_bf16_f32 v88, v160, v161
    v_cvt_pk_bf16_f32 v89, v162, v163
    ds_write_b64 v3, v[88:89] offset:6912
    v_pk_fma_f32 v[168:169], v[52:53], v[32:33], v[168:169] op_sel_hi:[1,0,1]
    v_pk_fma_f32 v[170:171], v[54:55], v[32:33], v[170:171] op_sel_hi:[1,0,1]
m_kernel_pad3:
    s_cbranch_execz m_kernel_pad4
    v_pk_mul_f32 v[168:169], v[168:169], v[32:33] op_sel:[0,1] op_sel_hi:[1,1]
    v_pk_mul_f32 v[170:171], v[170:171], v[32:33] op_sel:[0,1] op_sel_hi:[1,1]
    v_cvt_pk_bf16_f32 v90, v168, v169
    v_cvt_pk_bf16_f32 v91, v170, v171
    ds_write_b64 v2, v[90:91] offset:6912
    v_pk_fma_f32 v[172:173], v[56:57], v[32:33], v[172:173] op_sel_hi:[1,0,1]
    v_pk_fma_f32 v[174:175], v[58:59], v[32:33], v[174:175] op_sel_hi:[1,0,1]
    v_pk_mul_f32 v[172:173], v[172:173], v[32:33] op_sel:[0,1] op_sel_hi:[1,1]
    v_pk_mul_f32 v[174:175], v[174:175], v[32:33] op_sel:[0,1] op_sel_hi:[1,1]
    v_cvt_pk_bf16_f32 v92, v172, v173
    v_cvt_pk_bf16_f32 v93, v174, v175
    ds_write_b64 v2, v[92:93] offset:27648
    v_pk_fma_f32 v[176:177], v[60:61], v[32:33], v[176:177] op_sel_hi:[1,0,1]
    v_pk_fma_f32 v[178:179], v[62:63], v[32:33], v[178:179] op_sel_hi:[1,0,1]
    v_pk_mul_f32 v[176:177], v[176:177], v[32:33] op_sel:[0,1] op_sel_hi:[1,1]
    v_pk_mul_f32 v[178:179], v[178:179], v[32:33] op_sel:[0,1] op_sel_hi:[1,1]
    v_cvt_pk_bf16_f32 v94, v176, v177
    v_cvt_pk_bf16_f32 v95, v178, v179
    ds_write_b64 v3, v[94:95] offset:9216
    v_pk_fma_f32 v[184:185], v[52:53], v[36:37], v[184:185] op_sel_hi:[1,0,1]
    v_pk_fma_f32 v[186:187], v[54:55], v[36:37], v[186:187] op_sel_hi:[1,0,1]
    v_pk_mul_f32 v[184:185], v[184:185], v[36:37] op_sel:[0,1] op_sel_hi:[1,1]
    v_pk_mul_f32 v[186:187], v[186:187], v[36:37] op_sel:[0,1] op_sel_hi:[1,1]
    v_cvt_pk_bf16_f32 v96, v184, v185
    v_cvt_pk_bf16_f32 v97, v186, v187
    ds_write_b64 v2, v[96:97] offset:9216
    v_pk_fma_f32 v[188:189], v[56:57], v[36:37], v[188:189] op_sel_hi:[1,0,1]
    v_pk_fma_f32 v[190:191], v[58:59], v[36:37], v[190:191] op_sel_hi:[1,0,1]
    v_pk_mul_f32 v[188:189], v[188:189], v[36:37] op_sel:[0,1] op_sel_hi:[1,1]
    v_pk_mul_f32 v[190:191], v[190:191], v[36:37] op_sel:[0,1] op_sel_hi:[1,1]
    v_cvt_pk_bf16_f32 v98, v188, v189
    v_cvt_pk_bf16_f32 v99, v190, v191
    ds_write_b64 v2, v[98:99] offset:29952
    v_pk_fma_f32 v[192:193], v[60:61], v[36:37], v[192:193] op_sel_hi:[1,0,1]
    v_pk_fma_f32 v[194:195], v[62:63], v[36:37], v[194:195] op_sel_hi:[1,0,1]
    v_pk_mul_f32 v[192:193], v[192:193], v[36:37] op_sel:[0,1] op_sel_hi:[1,1]
    v_pk_mul_f32 v[194:195], v[194:195], v[36:37] op_sel:[0,1] op_sel_hi:[1,1]
    v_cvt_pk_bf16_f32 v100, v192, v193
    v_cvt_pk_bf16_f32 v101, v194, v195
    ds_write_b64 v3, v[100:101] offset:11520
    v_pk_fma_f32 v[200:201], v[52:53], v[40:41], v[200:201] op_sel_hi:[1,0,1]
    v_pk_fma_f32 v[202:203], v[54:55], v[40:41], v[202:203] op_sel_hi:[1,0,1]
    v_pk_mul_f32 v[200:201], v[200:201], v[40:41] op_sel:[0,1] op_sel_hi:[1,1]
    v_pk_mul_f32 v[202:203], v[202:203], v[40:41] op_sel:[0,1] op_sel_hi:[1,1]
    v_cvt_pk_bf16_f32 v102, v200, v201
    v_cvt_pk_bf16_f32 v103, v202, v203
    ds_write_b64 v2, v[102:103] offset:11520
    v_pk_fma_f32 v[204:205], v[56:57], v[40:41], v[204:205] op_sel_hi:[1,0,1]
    v_pk_fma_f32 v[206:207], v[58:59], v[40:41], v[206:207] op_sel_hi:[1,0,1]
    v_pk_mul_f32 v[204:205], v[204:205], v[40:41] op_sel:[0,1] op_sel_hi:[1,1]
    v_pk_mul_f32 v[206:207], v[206:207], v[40:41] op_sel:[0,1] op_sel_hi:[1,1]
    v_cvt_pk_bf16_f32 v104, v204, v205
    v_cvt_pk_bf16_f32 v105, v206, v207
    ds_write_b64 v2, v[104:105] offset:32256
    v_pk_fma_f32 v[208:209], v[60:61], v[40:41], v[208:209] op_sel_hi:[1,0,1]
    v_pk_fma_f32 v[210:211], v[62:63], v[40:41], v[210:211] op_sel_hi:[1,0,1]
    v_pk_mul_f32 v[208:209], v[208:209], v[40:41] op_sel:[0,1] op_sel_hi:[1,1]
    v_pk_mul_f32 v[210:211], v[210:211], v[40:41] op_sel:[0,1] op_sel_hi:[1,1]
    v_cvt_pk_bf16_f32 v106, v208, v209
    v_cvt_pk_bf16_f32 v107, v210, v211
    ds_write_b64 v3, v[106:107] offset:13824
    v_pk_fma_f32 v[216:217], v[52:53], v[44:45], v[216:217] op_sel_hi:[1,0,1]
    v_pk_fma_f32 v[218:219], v[54:55], v[44:45], v[218:219] op_sel_hi:[1,0,1]
    v_pk_mul_f32 v[216:217], v[216:217], v[44:45] op_sel:[0,1] op_sel_hi:[1,1]
    v_pk_mul_f32 v[218:219], v[218:219], v[44:45] op_sel:[0,1] op_sel_hi:[1,1]
    v_cvt_pk_bf16_f32 v108, v216, v217
    v_cvt_pk_bf16_f32 v109, v218, v219
    ds_write_b64 v2, v[108:109] offset:13824
    v_pk_fma_f32 v[220:221], v[56:57], v[44:45], v[220:221] op_sel_hi:[1,0,1]
    v_pk_fma_f32 v[222:223], v[58:59], v[44:45], v[222:223] op_sel_hi:[1,0,1]
    v_pk_mul_f32 v[220:221], v[220:221], v[44:45] op_sel:[0,1] op_sel_hi:[1,1]
    v_pk_mul_f32 v[222:223], v[222:223], v[44:45] op_sel:[0,1] op_sel_hi:[1,1]
    v_cvt_pk_bf16_f32 v110, v220, v221
    v_cvt_pk_bf16_f32 v111, v222, v223
    ds_write_b64 v2, v[110:111] offset:34560
    v_pk_fma_f32 v[224:225], v[60:61], v[44:45], v[224:225] op_sel_hi:[1,0,1]
    v_pk_fma_f32 v[226:227], v[62:63], v[44:45], v[226:227] op_sel_hi:[1,0,1]
    v_pk_mul_f32 v[224:225], v[224:225], v[44:45] op_sel:[0,1] op_sel_hi:[1,1]
    v_pk_mul_f32 v[226:227], v[226:227], v[44:45] op_sel:[0,1] op_sel_hi:[1,1]
    v_cvt_pk_bf16_f32 v112, v224, v225
    v_cvt_pk_bf16_f32 v113, v226, v227
    ds_write_b64 v3, v[112:113] offset:16128
    v_pk_fma_f32 v[232:233], v[52:53], v[48:49], v[232:233] op_sel_hi:[1,0,1]
    v_pk_fma_f32 v[234:235], v[54:55], v[48:49], v[234:235] op_sel_hi:[1,0,1]
    v_pk_mul_f32 v[232:233], v[232:233], v[48:49] op_sel:[0,1] op_sel_hi:[1,1]
    v_pk_mul_f32 v[234:235], v[234:235], v[48:49] op_sel:[0,1] op_sel_hi:[1,1]
    v_cvt_pk_bf16_f32 v114, v232, v233
    v_cvt_pk_bf16_f32 v115, v234, v235
    ds_write_b64 v2, v[114:115] offset:16128
    v_pk_fma_f32 v[236:237], v[56:57], v[48:49], v[236:237] op_sel_hi:[1,0,1]
    v_pk_fma_f32 v[238:239], v[58:59], v[48:49], v[238:239] op_sel_hi:[1,0,1]
    v_pk_mul_f32 v[236:237], v[236:237], v[48:49] op_sel:[0,1] op_sel_hi:[1,1]
    v_pk_mul_f32 v[238:239], v[238:239], v[48:49] op_sel:[0,1] op_sel_hi:[1,1]
    v_cvt_pk_bf16_f32 v116, v236, v237
    v_cvt_pk_bf16_f32 v117, v238, v239
    ds_write_b64 v2, v[116:117] offset:36864
    v_pk_fma_f32 v[240:241], v[60:61], v[48:49], v[240:241] op_sel_hi:[1,0,1]
    v_pk_fma_f32 v[242:243], v[62:63], v[48:49], v[242:243] op_sel_hi:[1,0,1]
    v_pk_mul_f32 v[240:241], v[240:241], v[48:49] op_sel:[0,1] op_sel_hi:[1,1]
    v_pk_mul_f32 v[242:243], v[242:243], v[48:49] op_sel:[0,1] op_sel_hi:[1,1]
    v_cvt_pk_bf16_f32 v118, v240, v241
    v_cvt_pk_bf16_f32 v119, v242, v243
    ds_write_b64 v3, v[118:119] offset:18432
    s_lshl_b32 s48, s4, 5
    s_add_u32 s47, s38, s48
    s_waitcnt lgkmcnt(0)
    v_and_b32 v2, 15, v1
    v_add_u32 v2, s47, v2
    v_mul_u32_u24 v2, 2048, v2
    v_bfe_u32 v3, v1, 4, 1
    v_lshrrev_b32 v4, 5, v1
    v_lshlrev_b32 v3, 5, v3
    v_lshl_add_u32 v3, v4, 4, v3
    v_add3_u32 v248, v2, v3, s39
    v_add_u32 v249, 32768, v248
    buffer_load_dwordx4 v[200:203], v248, s[20:23], 0 offen offset:0
    buffer_load_dwordx4 v[204:207], v248, s[20:23], 0 offen offset:64
    buffer_load_dwordx4 v[208:211], v249, s[20:23], 0 offen offset:0
    buffer_load_dwordx4 v[212:215], v249, s[20:23], 0 offen offset:64
m_kernel_attn:
    s_and_b32 s40, s3, 1
    s_lshr_b32 s41, s3, 1
    s_lshl_b32 s42, s41, 5
    s_add_u32 s42, s42, s40
    s_mul_i32 s43, s42, 144
    v_and_b32 v2, 15, v1
    v_lshrrev_b32 v3, 4, v1
    v_mul_u32_u24 v4, 288, v2
    v_lshl_add_u32 v4, v3, 4, v4
    v_add_u32 v6, s43, v4
    v_lshrrev_b32 v4, 2, v1
    v_mul_u32_u24 v4, 288, v4
    v_and_b32 v5, 3, v1
    v_lshl_add_u32 v4, v5, 3, v4
    s_add_u32 s44, s43, 39168
    v_add_u32 v7, s44, v4
    v_and_b32 v5, 1, v3
    v_lshrrev_b32 v11, 1, v3
    v_lshl_add_u32 v5, v5, 1, v11
    v_lshlrev_b32 v5, 11, v5
    v_lshl_add_u32 v5, v2, 4, v5
    s_lshl4_add_u32 s32, s36, s37
    s_lshl_b32 s32, s32, 14
    s_lshl_b32 s44, s3, 8
    s_add_u32 s44, s44, s32
    v_add_u32 v11, s44, v5
    v_lshlrev_b32 v12, 2, v3
    v_sub_u32 v13, v12, v2
    v_add_u32 v13, -1, v13
    s_or_b32 s44, s36, s41
    s_cmp_eq_u32 s44, 0
    s_cselect_b32 s45, 8, 0
    v_add_u32 v4, 0, v13
    v_cmp_gt_u32 vcc, 8, v4
    v_add_u32 v4, 0, v12
    v_cmp_le_u32 s[54:55], s45, v4
m_kernel_pad4:
    s_cbranch_execz m_kernel_pad5
    s_and_b64 s[54:55], vcc, s[54:55]
    v_add_u32 v4, 1, v13
    v_cmp_gt_u32 vcc, 8, v4
    v_add_u32 v4, 1, v12
    v_cmp_le_u32 s[56:57], s45, v4
    s_and_b64 s[56:57], vcc, s[56:57]
    v_add_u32 v4, 2, v13
    v_cmp_gt_u32 vcc, 8, v4
    v_add_u32 v4, 2, v12
    v_cmp_le_u32 s[58:59], s45, v4
    s_and_b64 s[58:59], vcc, s[58:59]
    v_add_u32 v4, 3, v13
    v_cmp_gt_u32 vcc, 8, v4
    v_add_u32 v4, 3, v12
    v_cmp_le_u32 s[60:61], s45, v4
    s_and_b64 s[60:61], vcc, s[60:61]
    v_add_u32 v4, 16, v13
    v_cmp_gt_u32 vcc, 8, v4
    s_mov_b64 s[62:63], vcc
    v_add_u32 v4, 17, v13
    v_cmp_gt_u32 vcc, 8, v4
    s_mov_b64 s[64:65], vcc
    v_add_u32 v4, 18, v13
    v_cmp_gt_u32 vcc, 8, v4
    s_mov_b64 s[66:67], vcc
    v_add_u32 v4, 19, v13
    v_cmp_gt_u32 vcc, 8, v4
    s_mov_b64 s[68:69], vcc
    v_mov_b32 v80, 0
    v_mov_b32 v100, 0
    v_mov_b32 v81, 0
    v_mov_b32 v101, 0
    v_mov_b32 v82, 0
    v_mov_b32 v102, 0
    v_mov_b32 v83, 0
    v_mov_b32 v103, 0
    v_mov_b32 v84, 0
    v_mov_b32 v104, 0
    v_mov_b32 v85, 0
    v_mov_b32 v105, 0
    v_mov_b32 v86, 0
    v_mov_b32 v106, 0
    v_mov_b32 v87, 0
    v_mov_b32 v107, 0
    v_mov_b32 v88, 0
    v_mov_b32 v108, 0
    v_mov_b32 v89, 0
    v_mov_b32 v109, 0
    v_mov_b32 v90, 0
    v_mov_b32 v110, 0
    v_mov_b32 v91, 0
    v_mov_b32 v111, 0
    v_mov_b32 v92, 0
    v_mov_b32 v112, 0
    v_mov_b32 v93, 0
    v_mov_b32 v113, 0
    v_mov_b32 v94, 0
    v_mov_b32 v114, 0
    v_mov_b32 v95, 0
    v_mov_b32 v115, 0
    v_mov_b32 v14, 0xff7fffff
    s_mov_b32 s46, 0x3e8293ee
    s_barrier
    ds_read_b128 v[16:19], v6 offset:0
    ds_read_b128 v[20:23], v6 offset:18432
    ds_read_b128 v[24:27], v6 offset:23040
    ds_read_b128 v[28:31], v6 offset:64
    ds_read_b128 v[32:35], v6 offset:18496
    ds_read_b128 v[36:39], v6 offset:23104
    ds_read_b64_tr_b16 v[48:49], v7 offset:0
    ds_read_b64_tr_b16 v[50:51], v7 offset:4608
    ds_read_b64_tr_b16 v[52:53], v7 offset:32
    ds_read_b64_tr_b16 v[54:55], v7 offset:4640
    ds_read_b64_tr_b16 v[56:57], v7 offset:64
    ds_read_b64_tr_b16 v[58:59], v7 offset:4672
    ds_read_b64_tr_b16 v[60:61], v7 offset:96
    ds_read_b64_tr_b16 v[62:63], v7 offset:4704
    s_cmp_lt_u32 s3, 4
    s_cbranch_scc1 m_kernel_nfh
    s_waitcnt vmcnt(1)
    s_add_u32 s40, s34, 0
    s_mov_b64 exec, 1
    v_mov_b32 v2, s5
    buffer_store_dword v2, off, s[16:19], s40 sc1
    s_mov_b64 exec, -1
m_kernel_nfh:
    s_waitcnt lgkmcnt(8)
    v_mfma_f32_16x16x32_bf16 v[80:83], v[20:23], v[16:19], v[80:83]
    v_mfma_f32_16x16x32_bf16 v[84:87], v[24:27], v[16:19], v[84:87]
    v_mfma_f32_16x16x32_bf16 v[88:91], v[32:35], v[28:31], v[88:91]
    v_mfma_f32_16x16x32_bf16 v[92:95], v[36:39], v[28:31], v[92:95]
    s_nop 7
    s_nop 1
    v_cndmask_b32 v80, v14, v80, s[54:55]
    v_cndmask_b32 v81, v14, v81, s[56:57]
    v_cndmask_b32 v82, v14, v82, s[58:59]
    v_cndmask_b32 v83, v14, v83, s[60:61]
    v_cndmask_b32 v84, v14, v84, s[62:63]
    v_cndmask_b32 v85, v14, v85, s[64:65]
    v_cndmask_b32 v86, v14, v86, s[66:67]
    v_cndmask_b32 v87, v14, v87, s[68:69]
    v_cndmask_b32 v88, v14, v88, s[54:55]
    v_cndmask_b32 v89, v14, v89, s[56:57]
    v_cndmask_b32 v90, v14, v90, s[58:59]
    v_cndmask_b32 v91, v14, v91, s[60:61]
    v_cndmask_b32 v92, v14, v92, s[62:63]
    v_cndmask_b32 v93, v14, v93, s[64:65]
    v_cndmask_b32 v94, v14, v94, s[66:67]
    v_cndmask_b32 v95, v14, v95, s[68:69]
    v_max3_f32 v64, v80, v81, v82
    v_max3_f32 v64, v64, v83, v84
    v_max3_f32 v64, v64, v85, v86
    v_max_f32 v64, v64, v87
    v_max3_f32 v65, v88, v89, v90
    v_max3_f32 v65, v65, v91, v92
    v_max3_f32 v65, v65, v93, v94
    v_max_f32 v65, v65, v95
    v_mov_b32 v66, v64
    s_nop 1
    v_permlane16_swap_b32 v66, v64
    v_max_f32 v64, v64, v66
    v_mov_b32 v66, v64
    s_nop 1
    v_permlane32_swap_b32 v66, v64
    v_max_f32 v64, v64, v66
    v_mov_b32 v67, v65
    s_nop 1
    v_permlane16_swap_b32 v67, v65
    v_max_f32 v65, v65, v67
    v_mov_b32 v67, v65
    s_nop 1
    v_permlane32_swap_b32 v67, v65
    v_max_f32 v65, v65, v67
    v_mul_f32 v64, s46, v64
    v_fma_f32 v80, v80, s46, -v64
    v_fma_f32 v81, v81, s46, -v64
    v_fma_f32 v82, v82, s46, -v64
    v_fma_f32 v83, v83, s46, -v64
    v_fma_f32 v84, v84, s46, -v64
    v_fma_f32 v85, v85, s46, -v64
    v_fma_f32 v86, v86, s46, -v64
    v_fma_f32 v87, v87, s46, -v64
    v_mul_f32 v65, s46, v65
    v_fma_f32 v88, v88, s46, -v65
    v_fma_f32 v89, v89, s46, -v65
    v_fma_f32 v90, v90, s46, -v65
    v_fma_f32 v91, v91, s46, -v65
    v_fma_f32 v92, v92, s46, -v65
    v_fma_f32 v93, v93, s46, -v65
    v_fma_f32 v94, v94, s46, -v65
    v_fma_f32 v95, v95, s46, -v65
    v_exp_f32 v80, v80
    v_exp_f32 v81, v81
    v_exp_f32 v82, v82
    v_exp_f32 v83, v83
    v_exp_f32 v84, v84
    v_exp_f32 v85, v85
    v_exp_f32 v86, v86
    v_exp_f32 v87, v87
    v_exp_f32 v88, v88
    v_exp_f32 v89, v89
    v_exp_f32 v90, v90
    v_exp_f32 v91, v91
    v_exp_f32 v92, v92
    v_exp_f32 v93, v93
    v_exp_f32 v94, v94
    v_exp_f32 v95, v95
    s_nop 0
    v_pk_add_f32 v[68:69], v[80:81], v[82:83]
    v_pk_add_f32 v[70:71], v[84:85], v[86:87]
    v_pk_add_f32 v[68:69], v[68:69], v[70:71]
    v_add_f32 v64, v68, v69
    v_pk_add_f32 v[68:69], v[88:89], v[90:91]
    v_pk_add_f32 v[70:71], v[92:93], v[94:95]
    v_pk_add_f32 v[68:69], v[68:69], v[70:71]
    v_add_f32 v66, v68, v69
    v_mov_b32 v65, v64
    s_nop 1
    v_permlane16_swap_b32 v65, v64
    v_add_f32 v64, v64, v65
    v_mov_b32 v65, v64
    s_nop 1
    v_permlane32_swap_b32 v65, v64
    v_add_f32 v64, v64, v65
    v_mov_b32 v67, v66
    s_nop 1
    v_permlane16_swap_b32 v67, v66
    v_add_f32 v66, v66, v67
    v_mov_b32 v67, v66
    s_nop 1
    v_permlane32_swap_b32 v67, v66
    v_add_f32 v66, v66, v67
    v_rcp_f32 v64, v64
    v_rcp_f32 v66, v66
    s_nop 0
    v_pk_mul_f32 v[80:81], v[80:81], v[64:65] op_sel_hi:[1,0]
    v_pk_mul_f32 v[82:83], v[82:83], v[64:65] op_sel_hi:[1,0]
    v_pk_mul_f32 v[84:85], v[84:85], v[64:65] op_sel_hi:[1,0]
    v_pk_mul_f32 v[86:87], v[86:87], v[64:65] op_sel_hi:[1,0]
    v_cvt_pk_bf16_f32 v68, v80, v81
    v_cvt_pk_bf16_f32 v69, v82, v83
    v_cvt_pk_bf16_f32 v70, v84, v85
    v_cvt_pk_bf16_f32 v71, v86, v87
m_kernel_pad5:
    s_cbranch_execz m_kernel_wret
    v_pk_mul_f32 v[88:89], v[88:89], v[66:67] op_sel_hi:[1,0]
    v_pk_mul_f32 v[90:91], v[90:91], v[66:67] op_sel_hi:[1,0]
    v_pk_mul_f32 v[92:93], v[92:93], v[66:67] op_sel_hi:[1,0]
    v_pk_mul_f32 v[94:95], v[94:95], v[66:67] op_sel_hi:[1,0]
    v_cvt_pk_bf16_f32 v72, v88, v89
    v_cvt_pk_bf16_f32 v73, v90, v91
    v_cvt_pk_bf16_f32 v74, v92, v93
    v_cvt_pk_bf16_f32 v75, v94, v95
    s_waitcnt lgkmcnt(0)
    s_nop 1
    v_mfma_f32_16x16x32_bf16 v[100:103], v[48:51], v[68:71], v[100:103]
    v_mfma_f32_16x16x32_bf16 v[104:107], v[52:55], v[68:71], v[104:107]
    v_mfma_f32_16x16x32_bf16 v[108:111], v[56:59], v[72:75], v[108:111]
    v_mfma_f32_16x16x32_bf16 v[112:115], v[60:63], v[72:75], v[112:115]
    s_mov_b32 s44, 0x900000
    s_nop 7
    s_nop 1
    v_cvt_pk_bf16_f32 v16, v100, v101
    v_cvt_pk_bf16_f32 v17, v102, v103
    v_cvt_pk_bf16_f32 v18, v104, v105
    v_cvt_pk_bf16_f32 v19, v106, v107
    s_nop 1
    v_permlane16_swap_b32 v16, v18
    v_permlane16_swap_b32 v17, v19
    buffer_store_dwordx4 v[16:19], v11, s[16:19], s44 offen sc1
    s_add_u32 s44, s44, 8192
    v_cvt_pk_bf16_f32 v20, v108, v109
    v_cvt_pk_bf16_f32 v21, v110, v111
    v_cvt_pk_bf16_f32 v22, v112, v113
    v_cvt_pk_bf16_f32 v23, v114, v115
    s_nop 1
    v_permlane16_swap_b32 v20, v22
    v_permlane16_swap_b32 v21, v23
    buffer_store_dwordx4 v[20:23], v11, s[16:19], s44 offen sc1
    s_add_u32 s44, s44, 8192
    s_lshr_b32 s33, s3, 2
    s_add_u32 s33, s33, s36
    s_lshl_b32 s33, s33, 8
    s_add_u32 s33, s33, 4096
    s_cmp_lt_u32 s3, 4
    s_cbranch_scc1 m_kernel_cons2
    v_min_u32 v2, 47, v1
    s_lshl_b32 s40, s36, 8
    s_sub_u32 s41, s40, 64
    v_lshl_add_u32 v2, v2, 3, s41
    v_max_i32 v2, 0, v2
    v_min_i32 v134, 4088, v2
    v_lshl_add_u32 v135, v1, 2, s40
    v_lshlrev_b32 v119, 1, v135
    v_and_b32 v2, 15, v1
    s_lshl_b32 s40, s37, 2
    v_lshl_add_u32 v2, v2, 9, s40
    v_lshrrev_b32 v3, 4, v1
    v_lshl_add_u32 v118, v3, 6, v2
    s_mov_b32 s20, s10
    s_mov_b32 s21, s11
    s_mov_b32 s22, 0x200000
    s_mov_b32 s23, 0x20000
    s_lshl_b32 s50, s4, 10
    s_add_u32 s50, s50, 81920
    s_mov_b32 s65, 0
    s_mov_b32 s63, 0x4031
    s_mov_b32 s62, 0x480060
    s_lshl_b32 s64, s36, 18
    s_add_u32 s67, s64, 0xd80000
    s_and_b32 s40, s36, 7
    s_mul_i32 s40, s40, 4
    s_lshr_b32 s40, s40, 3
    s_and_b32 s41, s37, 3
    s_mul_i32 s41, s41, 4
    s_lshr_b32 s41, s41, 2
    s_add_u32 s40, s40, s41
    s_and_b32 s68, s40, 3
    s_and_b32 s40, s36, 7
    s_mul_i32 s40, s40, 2
    s_lshr_b32 s40, s40, 3
    s_and_b32 s41, s37, 3
    s_mul_i32 s41, s41, 2
    s_lshr_b32 s41, s41, 2
    s_add_u32 s40, s40, s41
    s_and_b32 s69, s40, 1
    s_movk_i32 s41, 0x4000
    s_mov_b32 s40, 0x2700000
    buffer_load_dwordx2 v[20:21], v134, s[16:19], s40 offen sc1
    s_waitcnt vmcnt(0)
    s_add_u32 s40, s34, s33
    s_mov_b64 exec, 1
    v_mov_b32 v2, s5
    buffer_store_dword v2, off, s[16:19], s40 sc1
    s_mov_b64 exec, -1
    v_cmp_ne_u32 vcc, s5, v20
    v_cmp_ne_u32 s[42:43], s5, v21
    s_nop 1
    s_or_b64 vcc, vcc, s[42:43]
    s_nop 1
    s_cmp_eq_u64 vcc, 0
    s_cbranch_scc1 m_kernel_shd
m_kernel_sh:
    s_mov_b32 s40, 0x2700000
    buffer_load_dwordx2 v[20:21], v134, s[16:19], s40 offen sc1
    s_waitcnt vmcnt(0)
    v_cmp_ne_u32 vcc, s5, v20
    v_cmp_ne_u32 s[42:43], s5, v21
    s_nop 1
    s_or_b64 vcc, vcc, s[42:43]
    s_nop 1
    s_cmp_eq_u64 vcc, 0
    s_cbranch_scc1 m_kernel_shd
    s_sub_u32 s41, s41, 1
    s_cbranch_scc0 m_kernel_sh
m_kernel_shd:
    s_mov_b32 s52, 0
m_kernel_la0:
    s_xor_b32 s61, s65, s68
    s_and_b32 s42, s61, 12
    s_lshr_b32 s42, s63, s42
    s_and_b32 s42, s42, 15
    s_mul_i32 s60, s61, 263168
    s_lshl4_add_u32 s60, s42, s60
    s_add_u32 s60, s60, s62
    s_lshl_b32 s61, s61, 17
    s_add_u32 m0, s50, 16384
    s_nop 0
    buffer_load_dwordx4 v132, s[20:23], s61 offen  lds
    s_add_u32 m0, s50, 20480
    s_nop 0
    buffer_load_dwordx4 v133, s[20:23], s61 offen  lds
    s_add_u32 m0, s50, 0
    s_nop 0
    buffer_load_dwordx4 v124, s[16:19], s60 offen sc1 lds
    s_add_u32 m0, s50, 4096
    s_nop 0
    buffer_load_dwordx4 v125, s[16:19], s60 offen sc1 lds
    s_add_u32 m0, s50, 8192
    s_nop 0
    buffer_load_dwordx4 v126, s[16:19], s60 offen sc1 lds
    s_add_u32 m0, s50, 12288
    s_nop 0
    buffer_load_dwordx4 v127, s[16:19], s60 offen sc1 lds
    s_add_u32 s65, s65, 1
    s_add_u32 s50, s50, 24576
    s_cmp_ge_u32 s50, 155648
    s_cselect_b32 s51, 147456, 0
    s_sub_u32 s50, s50, s51
    s_add_u32 s52, s52, 1
    s_cmp_lg_u32 s52, 3
    s_cbranch_scc1 m_kernel_la1
    s_waitcnt vmcnt(12)
    s_barrier
m_kernel_la1:
    s_cmp_lt_u32 s52, 6
    s_cbranch_scc1 m_kernel_la0
    s_mov_b32 s52, 1
m_kernel_la2:
    s_waitcnt vmcnt(24)
    s_barrier
    s_xor_b32 s61, s65, s68
    s_and_b32 s42, s61, 12
    s_lshr_b32 s42, s63, s42
    s_and_b32 s42, s42, 15
    s_mul_i32 s60, s61, 263168
    s_lshl4_add_u32 s60, s42, s60
    s_add_u32 s60, s60, s62
    s_lshl_b32 s61, s61, 17
    s_add_u32 m0, s50, 16384
    s_nop 0
    buffer_load_dwordx4 v132, s[20:23], s61 offen  lds
    s_add_u32 m0, s50, 20480
    s_nop 0
    buffer_load_dwordx4 v133, s[20:23], s61 offen  lds
    s_add_u32 m0, s50, 0
    s_nop 0
    buffer_load_dwordx4 v124, s[16:19], s60 offen sc1 lds
    s_add_u32 m0, s50, 4096
    s_nop 0
    buffer_load_dwordx4 v125, s[16:19], s60 offen sc1 lds
    s_add_u32 m0, s50, 8192
    s_nop 0
    buffer_load_dwordx4 v126, s[16:19], s60 offen sc1 lds
    s_add_u32 m0, s50, 12288
    s_nop 0
    buffer_load_dwordx4 v127, s[16:19], s60 offen sc1 lds
    s_add_u32 s65, s65, 1
    s_add_u32 s50, s50, 24576
    s_cmp_ge_u32 s50, 155648
    s_cselect_b32 s51, 147456, 0
    s_sub_u32 s50, s50, s51
    s_add_u32 s52, s52, 1
    s_cmp_lt_u32 s52, 5
    s_cbranch_scc1 m_kernel_la2
    s_mov_b32 s40, 0x2701000
    buffer_load_dwordx2 v[22:23], v119, s[16:19], s40 offen sc1
    s_mov_b32 s40, 0x2701100
    buffer_load_dword v24, v118, s[16:19], s40 offen sc1
    s_mov_b32 s52, 5
m_kernel_la3:
    s_waitcnt vmcnt(24)
    s_barrier
    s_xor_b32 s61, s65, s68
    s_and_b32 s42, s61, 12
    s_lshr_b32 s42, s63, s42
    s_and_b32 s42, s42, 15
    s_mul_i32 s60, s61, 263168
    s_lshl4_add_u32 s60, s42, s60
    s_add_u32 s60, s60, s62
    s_lshl_b32 s61, s61, 17
    s_add_u32 m0, s50, 16384
    s_nop 0
    buffer_load_dwordx4 v132, s[20:23], s61 offen  lds
    s_add_u32 m0, s50, 20480
    s_nop 0
    buffer_load_dwordx4 v133, s[20:23], s61 offen  lds
    s_add_u32 m0, s50, 0
    s_nop 0
    buffer_load_dwordx4 v124, s[16:19], s60 offen sc1 lds
    s_add_u32 m0, s50, 4096
    s_nop 0
    buffer_load_dwordx4 v125, s[16:19], s60 offen sc1 lds
    s_add_u32 m0, s50, 8192
    s_nop 0
    buffer_load_dwordx4 v126, s[16:19], s60 offen sc1 lds
    s_add_u32 m0, s50, 12288
    s_nop 0
    buffer_load_dwordx4 v127, s[16:19], s60 offen sc1 lds
    s_add_u32 s65, s65, 1
    s_add_u32 s50, s50, 24576
    s_cmp_ge_u32 s50, 155648
    s_cselect_b32 s51, 147456, 0
    s_sub_u32 s50, s50, s51
    s_add_u32 s52, s52, 1
    s_cmp_lt_u32 s52, 11
    s_cbranch_scc1 m_kernel_la3
m_kernel_pad6:
    s_cbranch_execz m_kernel_pad7
    s_lshl_b32 s40, s4, 6
    s_add_u32 s40, s40, 0
    v_add_u32 v2, s40, v1
    v_mul_u32_u24 v3, 2341, v2
    v_lshrrev_b32 v3, 16, v3
    v_mul_u32_u24 v4, 28, v3
    v_sub_u32 v2, v2, v4
    v_bfe_u32 v4, v3, 3, 1
    v_lshlrev_b32 v4, 1, v4
    v_xor_b32 v2, v2, v4
    v_mul_u32_u24 v3, 7168, v3
    v_lshl_add_u32 v2, v2, 4, v3
    v_add_u32 v12, s35, v2
    s_lshl_b32 s40, s4, 6
    s_add_u32 s40, s40, 256
    v_add_u32 v2, s40, v1
    v_mul_u32_u24 v3, 2341, v2
    v_lshrrev_b32 v3, 16, v3
    v_mul_u32_u24 v4, 28, v3
    v_sub_u32 v2, v2, v4
    v_bfe_u32 v4, v3, 3, 1
    v_lshlrev_b32 v4, 1, v4
    v_xor_b32 v2, v2, v4
    v_mul_u32_u24 v3, 7168, v3
    v_lshl_add_u32 v2, v2, 4, v3
    v_add_u32 v13, s35, v2
    s_lshl_b32 s40, s4, 6
    s_add_u32 s40, s40, 512
    v_add_u32 v2, s40, v1
    v_mul_u32_u24 v3, 2341, v2
    v_lshrrev_b32 v3, 16, v3
    v_mul_u32_u24 v4, 28, v3
    v_sub_u32 v2, v2, v4
    v_bfe_u32 v4, v3, 3, 1
    v_lshlrev_b32 v4, 1, v4
    v_xor_b32 v2, v2, v4
    v_mul_u32_u24 v3, 7168, v3
    v_lshl_add_u32 v2, v2, 4, v3
    v_add_u32 v14, s35, v2
    s_lshl_b32 s40, s4, 6
    s_add_u32 s40, s40, 768
    v_add_u32 v2, s40, v1
    v_mul_u32_u24 v3, 2341, v2
    v_lshrrev_b32 v3, 16, v3
    v_mul_u32_u24 v4, 28, v3
    v_sub_u32 v2, v2, v4
    v_bfe_u32 v4, v3, 3, 1
    v_lshlrev_b32 v4, 1, v4
    v_xor_b32 v2, v2, v4
    v_mul_u32_u24 v3, 7168, v3
    v_lshl_add_u32 v2, v2, 4, v3
    v_add_u32 v15, s35, v2
    s_lshl_b32 s40, s4, 6
    s_add_u32 s40, s40, 1024
    v_add_u32 v2, s40, v1
    v_mul_u32_u24 v3, 2341, v2
    v_lshrrev_b32 v3, 16, v3
    v_mul_u32_u24 v4, 28, v3
    v_sub_u32 v2, v2, v4
    v_bfe_u32 v4, v3, 3, 1
    v_lshlrev_b32 v4, 1, v4
    v_xor_b32 v2, v2, v4
    v_mul_u32_u24 v3, 7168, v3
    v_lshl_add_u32 v2, v2, 4, v3
    v_add_u32 v16, s35, v2
    s_lshl_b32 s40, s4, 6
    s_add_u32 s40, s40, 1280
    v_add_u32 v2, s40, v1
    v_mul_u32_u24 v3, 2341, v2
    v_lshrrev_b32 v3, 16, v3
    v_mul_u32_u24 v4, 28, v3
    v_sub_u32 v2, v2, v4
    v_bfe_u32 v4, v3, 3, 1
    v_lshlrev_b32 v4, 1, v4
    v_xor_b32 v2, v2, v4
    v_mul_u32_u24 v3, 7168, v3
    v_lshl_add_u32 v2, v2, 4, v3
    v_add_u32 v17, s35, v2
    s_lshl_b32 s40, s4, 6
    s_add_u32 s40, s40, 1536
    v_add_u32 v2, s40, v1
    v_mul_u32_u24 v3, 2341, v2
    v_lshrrev_b32 v3, 16, v3
    v_mul_u32_u24 v4, 28, v3
    v_sub_u32 v2, v2, v4
    v_bfe_u32 v4, v3, 3, 1
    v_lshlrev_b32 v4, 1, v4
    v_xor_b32 v2, v2, v4
    v_mul_u32_u24 v3, 7168, v3
    v_lshl_add_u32 v2, v2, 4, v3
    v_add_u32 v18, s35, v2
    s_mov_b32 s24, s14
    s_mov_b32 s25, s15
    s_mov_b32 s26, 0x700000
    s_mov_b32 s27, 0x20000
    v_cmp_ne_u32 vcc, s5, v22
    v_cmp_ne_u32 s[42:43], s5, v23
    s_nop 1
    s_or_b64 vcc, vcc, s[42:43]
    s_nop 1
    s_cmp_eq_u64 vcc, 0
    s_cbranch_scc1 m_kernel_sod
    s_movk_i32 s41, 0x4000
m_kernel_so:
    s_mov_b32 s40, 0x2701000
    buffer_load_dwordx2 v[20:21], v119, s[16:19], s40 offen sc1
    s_waitcnt vmcnt(0)
    v_cmp_ne_u32 vcc, s5, v20
    v_cmp_ne_u32 s[42:43], s5, v21
    s_nop 1
    s_or_b64 vcc, vcc, s[42:43]
    s_nop 1
    s_cmp_eq_u64 vcc, 0
    s_cbranch_scc1 m_kernel_sod
    s_sub_u32 s41, s41, 1
    s_cbranch_scc0 m_kernel_so
m_kernel_sod:
    v_cmp_ne_u32 vcc, s5, v24
    s_nop 1
    s_cmp_eq_u64 vcc, 0
    s_cbranch_scc1 m_kernel_scd
    s_movk_i32 s41, 0x4000
m_kernel_sc:
    s_mov_b32 s40, 0x2701100
    buffer_load_dword v20, v118, s[16:19], s40 offen sc1
    s_waitcnt vmcnt(0)
    v_cmp_ne_u32 vcc, s5, v20
    s_nop 1
    s_cmp_eq_u64 vcc, 0
    s_cbranch_scc1 m_kernel_scd
    s_sub_u32 s41, s41, 1
    s_cbranch_scc0 m_kernel_sc
m_kernel_scd:
    s_mov_b32 s20, s8
    s_mov_b32 s21, s9
    s_mov_b32 s65, 0
    s_add_u32 s62, s64, 0x900000
    s_mov_b32 s52, 11
m_kernel_la4:
    s_waitcnt vmcnt(24)
    s_barrier
    s_xor_b32 s61, s65, s68
    s_lshl_b32 s60, s61, 14
    s_add_u32 s60, s60, s62
    s_lshl_b32 s61, s61, 17
    s_add_u32 m0, s50, 16384
    s_nop 0
    buffer_load_dwordx4 v132, s[20:23], s61 offen  lds
    s_add_u32 m0, s50, 20480
    s_nop 0
    buffer_load_dwordx4 v133, s[20:23], s61 offen  lds
    s_add_u32 m0, s50, 0
    s_nop 0
    buffer_load_dwordx4 v136, s[16:19], s60 offen sc1 lds
    s_add_u32 m0, s50, 4096
    s_nop 0
    buffer_load_dwordx4 v137, s[16:19], s60 offen sc1 lds
    s_add_u32 m0, s50, 8192
    s_nop 0
    buffer_load_dwordx4 v138, s[16:19], s60 offen sc1 lds
    s_add_u32 m0, s50, 12288
    s_nop 0
    buffer_load_dwordx4 v139, s[16:19], s60 offen sc1 lds
    s_add_u32 s65, s65, 1
    s_add_u32 s50, s50, 24576
    s_cmp_ge_u32 s50, 155648
    s_cselect_b32 s51, 147456, 0
    s_sub_u32 s50, s50, s51
    s_add_u32 s52, s52, 1
    s_cmp_lt_u32 s52, 18
    s_cbranch_scc1 m_kernel_la4
    s_lshl_b32 s50, s4, 10
    s_waitcnt vmcnt(24)
    s_barrier
    s_waitcnt vmcnt(18)
    s_barrier
    s_xor_b32 s61, s69, 0
    s_mul_i32 s61, s61, 458752
    s_add_u32 m0, s50, 73728
    s_nop 0
    buffer_load_dwordx4 v12, s[24:27], s61 offen  lds
    s_add_u32 m0, s50, 77824
    s_nop 0
    buffer_load_dwordx4 v13, s[24:27], s61 offen  lds
    s_add_u32 m0, s50, 81920
    s_nop 0
    buffer_load_dwordx4 v14, s[24:27], s61 offen  lds
    s_add_u32 m0, s50, 86016
    s_nop 0
    buffer_load_dwordx4 v15, s[24:27], s61 offen  lds
    s_add_u32 m0, s50, 90112
    s_nop 0
    buffer_load_dwordx4 v16, s[24:27], s61 offen  lds
    s_add_u32 m0, s50, 94208
    s_nop 0
    buffer_load_dwordx4 v17, s[24:27], s61 offen  lds
    s_add_u32 m0, s50, 98304
    s_nop 0
    buffer_load_dwordx4 v18, s[24:27], s61 offen  lds
    s_waitcnt vmcnt(19)
    s_barrier
    s_waitcnt vmcnt(13)
    s_barrier
    s_xor_b32 s61, s69, 1
    s_mul_i32 s61, s61, 458752
    s_add_u32 m0, s50, 122880
    s_nop 0
    buffer_load_dwordx4 v12, s[24:27], s61 offen  lds
m_kernel_pad7:
    s_cbranch_execz m_kernel_pad8
    s_add_u32 m0, s50, 126976
    s_nop 0
    buffer_load_dwordx4 v13, s[24:27], s61 offen  lds
    s_add_u32 m0, s50, 131072
    s_nop 0
    buffer_load_dwordx4 v14, s[24:27], s61 offen  lds
    s_add_u32 m0, s50, 135168
    s_nop 0
    buffer_load_dwordx4 v15, s[24:27], s61 offen  lds
    s_add_u32 m0, s50, 139264
    s_nop 0
    buffer_load_dwordx4 v16, s[24:27], s61 offen  lds
    s_add_u32 m0, s50, 143360
    s_nop 0
    buffer_load_dwordx4 v17, s[24:27], s61 offen  lds
    s_add_u32 m0, s50, 147456
    s_nop 0
    buffer_load_dwordx4 v18, s[24:27], s61 offen  lds
    s_waitcnt vmcnt(14)
    s_barrier
    s_movk_i32 s41, 0x4000
m_kernel_sx:
    s_mov_b32 s40, 0x2703000
    buffer_load_dword v20, v135, s[16:19], s40 offen sc1
    s_waitcnt vmcnt(0)
    v_cmp_ne_u32 vcc, s5, v20
    s_nop 1
    s_cmp_eq_u64 vcc, 0
    s_cbranch_scc1 m_kernel_sxd
    s_sub_u32 s41, s41, 1
    s_cbranch_scc0 m_kernel_sx
m_kernel_sxd:
    s_xor_b32 s60, s69, 0
    s_lshl_b32 s60, s60, 14
    s_add_u32 s60, s60, s67
    s_add_u32 m0, s50, 57344
    s_nop 0
    buffer_load_dwordx4 v128, s[16:19], s60 offen sc1 lds
    s_add_u32 m0, s50, 61440
    s_nop 0
    buffer_load_dwordx4 v129, s[16:19], s60 offen sc1 lds
    s_add_u32 m0, s50, 65536
    s_nop 0
    buffer_load_dwordx4 v130, s[16:19], s60 offen sc1 lds
    s_add_u32 m0, s50, 69632
    s_nop 0
    buffer_load_dwordx4 v131, s[16:19], s60 offen sc1 lds
    s_xor_b32 s60, s69, 1
    s_lshl_b32 s60, s60, 14
    s_add_u32 s60, s60, s67
    s_add_u32 m0, s50, 106496
    s_nop 0
    buffer_load_dwordx4 v128, s[16:19], s60 offen sc1 lds
    s_add_u32 m0, s50, 110592
    s_nop 0
    buffer_load_dwordx4 v129, s[16:19], s60 offen sc1 lds
    s_add_u32 m0, s50, 114688
    s_nop 0
    buffer_load_dwordx4 v130, s[16:19], s60 offen sc1 lds
    s_add_u32 m0, s50, 118784
    s_nop 0
    buffer_load_dwordx4 v131, s[16:19], s60 offen sc1 lds
    s_barrier
    s_xor_b32 s61, s69, 2
    s_mul_i32 s61, s61, 458752
    s_add_u32 m0, s50, 24576
    s_nop 0
    buffer_load_dwordx4 v12, s[24:27], s61 offen  lds
    s_add_u32 m0, s50, 28672
    s_nop 0
    buffer_load_dwordx4 v13, s[24:27], s61 offen  lds
    s_add_u32 m0, s50, 32768
    s_nop 0
    buffer_load_dwordx4 v14, s[24:27], s61 offen  lds
    s_add_u32 m0, s50, 36864
    s_nop 0
    buffer_load_dwordx4 v15, s[24:27], s61 offen  lds
    s_add_u32 m0, s50, 40960
    s_nop 0
    buffer_load_dwordx4 v16, s[24:27], s61 offen  lds
    s_add_u32 m0, s50, 45056
    s_nop 0
    buffer_load_dwordx4 v17, s[24:27], s61 offen  lds
    s_add_u32 m0, s50, 49152
    s_nop 0
    buffer_load_dwordx4 v18, s[24:27], s61 offen  lds
    s_xor_b32 s60, s69, 2
    s_lshl_b32 s60, s60, 14
    s_add_u32 s60, s60, s67
    s_add_u32 m0, s50, 8192
    s_nop 0
    buffer_load_dwordx4 v128, s[16:19], s60 offen sc1 lds
    s_add_u32 m0, s50, 12288
    s_nop 0
    buffer_load_dwordx4 v129, s[16:19], s60 offen sc1 lds
    s_add_u32 m0, s50, 16384
    s_nop 0
    buffer_load_dwordx4 v130, s[16:19], s60 offen sc1 lds
    s_add_u32 m0, s50, 20480
    s_nop 0
    buffer_load_dwordx4 v131, s[16:19], s60 offen sc1 lds
    s_add_u32 s50, s50, 57344
    s_mov_b32 s66, 3
    s_waitcnt vmcnt(15)
    s_barrier
    s_waitcnt vmcnt(11)
    s_mov_b32 s52, 1
m_kernel_l3:
    s_waitcnt vmcnt(11)
    s_barrier
    s_xor_b32 s61, s66, s69
    s_lshl_b32 s60, s61, 14
    s_add_u32 s60, s60, s67
    s_mul_i32 s61, s61, 458752
    s_add_u32 m0, s50, 16384
    s_nop 0
    buffer_load_dwordx4 v12, s[24:27], s61 offen  lds
    s_add_u32 m0, s50, 0
    s_nop 0
    buffer_load_dwordx4 v128, s[16:19], s60 offen sc1 lds
    s_add_u32 m0, s50, 20480
    s_nop 0
    buffer_load_dwordx4 v13, s[24:27], s61 offen  lds
    s_add_u32 m0, s50, 4096
    s_nop 0
    buffer_load_dwordx4 v129, s[16:19], s60 offen sc1 lds
    s_add_u32 m0, s50, 24576
    s_nop 0
    buffer_load_dwordx4 v14, s[24:27], s61 offen  lds
    s_add_u32 m0, s50, 8192
    s_nop 0
    buffer_load_dwordx4 v130, s[16:19], s60 offen sc1 lds
    s_add_u32 m0, s50, 28672
    s_nop 0
    buffer_load_dwordx4 v15, s[24:27], s61 offen  lds
    s_add_u32 m0, s50, 12288
    s_nop 0
    buffer_load_dwordx4 v131, s[16:19], s60 offen sc1 lds
    s_add_u32 m0, s50, 32768
    s_nop 0
    buffer_load_dwordx4 v16, s[24:27], s61 offen  lds
    s_add_u32 m0, s50, 36864
    s_nop 0
    buffer_load_dwordx4 v17, s[24:27], s61 offen  lds
    s_add_u32 m0, s50, 40960
    s_nop 0
    buffer_load_dwordx4 v18, s[24:27], s61 offen  lds
    s_add_u32 s66, s66, 1
    s_add_u32 s50, s50, 49152
    s_cmp_ge_u32 s50, 155648
    s_cselect_b32 s51, 147456, 0
    s_sub_u32 s50, s50, s51
    s_add_u32 s52, s52, 1
    s_cmp_lt_u32 s52, 14
    s_cbranch_scc1 m_kernel_l3
    s_and_b32 s40, s4, 1
    s_lshl_b32 s40, s40, 9
    v_lshlrev_b32 v20, 3, v1
    v_add_u32 v20, s40, v20
    s_lshl_b32 s41, s38, 3
    s_add_u32 s41, s41, 0x2640000
    s_lshl_b32 s42, s35, 1
    s_add_u32 s42, s42, 0x2600000
    s_cmp_lt_u32 s4, 2
    s_cselect_b32 s41, s41, s42
    s_mov_b32 s42, 14336
    s_cselect_b32 s42, 16384, s42
    buffer_load_dwordx2 v[24:25], v20, s[16:19], s41 offen sc1
    s_add_i32 s41, s41, s42
    buffer_load_dwordx2 v[26:27], v20, s[16:19], s41 offen sc1
    s_add_i32 s41, s41, s42
    buffer_load_dwordx2 v[28:29], v20, s[16:19], s41 offen sc1
    s_add_i32 s41, s41, s42
    buffer_load_dwordx2 v[30:31], v20, s[16:19], s41 offen sc1
    s_add_i32 s41, s41, s42
    buffer_load_dwordx2 v[32:33], v20, s[16:19], s41 offen sc1
    s_add_i32 s41, s41, s42
    buffer_load_dwordx2 v[34:35], v20, s[16:19], s41 offen sc1
    s_add_i32 s41, s41, s42
    buffer_load_dwordx2 v[36:37], v20, s[16:19], s41 offen sc1
    s_add_i32 s41, s41, s42
    buffer_load_dwordx2 v[38:39], v20, s[16:19], s41 offen sc1
    s_add_i32 s41, s41, s42
    buffer_load_dwordx2 v[40:41], v20, s[16:19], s41 offen sc1
    s_add_i32 s41, s41, s42
    buffer_load_dwordx2 v[42:43], v20, s[16:19], s41 offen sc1
m_kernel_pad8:
    s_cbranch_execz m_kernel_wret
    s_add_i32 s41, s41, s42
    buffer_load_dwordx2 v[44:45], v20, s[16:19], s41 offen sc1
    s_add_i32 s41, s41, s42
    buffer_load_dwordx2 v[46:47], v20, s[16:19], s41 offen sc1
    s_add_i32 s41, s41, s42
    buffer_load_dwordx2 v[48:49], v20, s[16:19], s41 offen sc1
    s_add_i32 s41, s41, s42
    buffer_load_dwordx2 v[50:51], v20, s[16:19], s41 offen sc1
    s_add_i32 s41, s41, s42
    buffer_load_dwordx2 v[52:53], v20, s[16:19], s41 offen sc1
    s_add_i32 s41, s41, s42
    buffer_load_dwordx2 v[54:55], v20, s[16:19], s41 offen sc1
    s_lshl_b32 s50, s4, 10
    s_add_u32 s50, s50, 106496
    s_waitcnt vmcnt(27)
    s_barrier
    s_xor_b32 s61, s65, s68
    s_lshl_b32 s60, s61, 14
    s_add_u32 s60, s60, s62
    s_lshl_b32 s61, s61, 17
    s_add_u32 m0, s50, 16384
    s_nop 0
    buffer_load_dwordx4 v132, s[20:23], s61 offen  lds
    s_add_u32 m0, s50, 20480
    s_nop 0
    buffer_load_dwordx4 v133, s[20:23], s61 offen  lds
    s_add_u32 m0, s50, 0
    s_nop 0
    buffer_load_dwordx4 v136, s[16:19], s60 offen sc1 lds
    s_add_u32 m0, s50, 4096
    s_nop 0
    buffer_load_dwordx4 v137, s[16:19], s60 offen sc1 lds
    s_add_u32 m0, s50, 8192
    s_nop 0
    buffer_load_dwordx4 v138, s[16:19], s60 offen sc1 lds
    s_add_u32 m0, s50, 12288
    s_nop 0
    buffer_load_dwordx4 v139, s[16:19], s60 offen sc1 lds
    s_add_u32 s65, s65, 1
    s_add_u32 s50, s50, 24576
    s_cmp_ge_u32 s50, 155648
    s_cselect_b32 s51, 147456, 0
    s_sub_u32 s50, s50, s51
    s_xor_b32 s61, s65, s68
    s_lshl_b32 s60, s61, 14
    s_add_u32 s60, s60, s62
    s_lshl_b32 s61, s61, 17
    s_add_u32 m0, s50, 16384
    s_nop 0
    buffer_load_dwordx4 v132, s[20:23], s61 offen  lds
    s_add_u32 m0, s50, 20480
    s_nop 0
    buffer_load_dwordx4 v133, s[20:23], s61 offen  lds
    s_add_u32 m0, s50, 0
    s_nop 0
    buffer_load_dwordx4 v136, s[16:19], s60 offen sc1 lds
    s_add_u32 m0, s50, 4096
    s_nop 0
    buffer_load_dwordx4 v137, s[16:19], s60 offen sc1 lds
    s_add_u32 m0, s50, 8192
    s_nop 0
    buffer_load_dwordx4 v138, s[16:19], s60 offen sc1 lds
    s_add_u32 m0, s50, 12288
    s_nop 0
    buffer_load_dwordx4 v139, s[16:19], s60 offen sc1 lds
    s_add_u32 s65, s65, 1
    s_add_u32 s50, s50, 24576
    s_cmp_ge_u32 s50, 155648
    s_cselect_b32 s51, 147456, 0
    s_sub_u32 s50, s50, s51
    s_waitcnt vmcnt(28)
    s_barrier
    s_xor_b32 s61, s65, s68
    s_lshl_b32 s60, s61, 14
    s_add_u32 s60, s60, s62
    s_lshl_b32 s61, s61, 17
    s_add_u32 m0, s50, 16384
    s_nop 0
    buffer_load_dwordx4 v132, s[20:23], s61 offen  lds
    s_add_u32 m0, s50, 20480
    s_nop 0
    buffer_load_dwordx4 v133, s[20:23], s61 offen  lds
    s_add_u32 m0, s50, 0
    s_nop 0
    buffer_load_dwordx4 v136, s[16:19], s60 offen sc1 lds
    s_add_u32 m0, s50, 4096
    s_nop 0
    buffer_load_dwordx4 v137, s[16:19], s60 offen sc1 lds
    s_add_u32 m0, s50, 8192
    s_nop 0
    buffer_load_dwordx4 v138, s[16:19], s60 offen sc1 lds
    s_add_u32 m0, s50, 12288
    s_nop 0
    buffer_load_dwordx4 v139, s[16:19], s60 offen sc1 lds
    s_add_u32 s65, s65, 1
    s_add_u32 s50, s50, 24576
    s_cmp_ge_u32 s50, 155648
    s_cselect_b32 s51, 147456, 0
    s_sub_u32 s50, s50, s51
    s_xor_b32 s61, s65, s68
    s_lshl_b32 s60, s61, 14
    s_add_u32 s60, s60, s62
    s_lshl_b32 s61, s61, 17
    s_add_u32 m0, s50, 16384
    s_nop 0
    buffer_load_dwordx4 v132, s[20:23], s61 offen  lds
    s_add_u32 m0, s50, 20480
    s_nop 0
    buffer_load_dwordx4 v133, s[20:23], s61 offen  lds
    s_add_u32 m0, s50, 0
    s_nop 0
    buffer_load_dwordx4 v136, s[16:19], s60 offen sc1 lds
    s_add_u32 m0, s50, 4096
    s_nop 0
    buffer_load_dwordx4 v137, s[16:19], s60 offen sc1 lds
    s_add_u32 m0, s50, 8192
    s_nop 0
    buffer_load_dwordx4 v138, s[16:19], s60 offen sc1 lds
    s_add_u32 m0, s50, 12288
    s_nop 0
    buffer_load_dwordx4 v139, s[16:19], s60 offen sc1 lds
    s_add_u32 s65, s65, 1
    s_add_u32 s50, s50, 24576
    s_cmp_ge_u32 s50, 155648
    s_cselect_b32 s51, 147456, 0
    s_sub_u32 s50, s50, s51
    s_waitcnt vmcnt(24)
    v_pk_add_f32 v[24:25], v[24:25], v[26:27]
    v_pk_add_f32 v[24:25], v[24:25], v[28:29]
    v_pk_add_f32 v[24:25], v[24:25], v[30:31]
    v_pk_add_f32 v[24:25], v[24:25], v[32:33]
    v_pk_add_f32 v[24:25], v[24:25], v[34:35]
    v_pk_add_f32 v[24:25], v[24:25], v[36:37]
    v_pk_add_f32 v[24:25], v[24:25], v[38:39]
    v_pk_add_f32 v[24:25], v[24:25], v[40:41]
    v_pk_add_f32 v[24:25], v[24:25], v[42:43]
    v_pk_add_f32 v[24:25], v[24:25], v[44:45]
    v_pk_add_f32 v[24:25], v[24:25], v[46:47]
    v_pk_add_f32 v[24:25], v[24:25], v[48:49]
    v_pk_add_f32 v[24:25], v[24:25], v[50:51]
    v_pk_add_f32 v[24:25], v[24:25], v[52:53]
    v_pk_add_f32 v[24:25], v[24:25], v[54:55]
    s_cmp_lt_u32 s4, 2
    s_cbranch_scc0 m_kernel_tcs
    v_mul_f32 v24, 0x3a800000, v24
    v_mul_f32 v25, 0x3a800000, v25
    v_fma_f32 v25, -v24, v24, v25
    v_max_f32 v25, 0, v25
    v_add_f32 v25, 0x3727c5ac, v25
    v_rsq_f32 v25, v25
    s_nop 0
    v_mul_f32 v24, -v24, v25
    v_subrev_u32 v20, 1024, v20
m_kernel_tcs:
    v_add_u32 v20, 156672, v20
    ds_write_b64 v20, v[24:25]
    s_waitcnt lgkmcnt(0)
    s_barrier
    s_xor_b32 s61, s65, s68
    s_lshl_b32 s60, s61, 14
    s_add_u32 s60, s60, s62
    s_lshl_b32 s61, s61, 17
    s_add_u32 m0, s50, 16384
    s_nop 0
    buffer_load_dwordx4 v132, s[20:23], s61 offen  lds
    s_add_u32 m0, s50, 20480
    s_nop 0
    buffer_load_dwordx4 v133, s[20:23], s61 offen  lds
    s_add_u32 m0, s50, 0
    s_nop 0
    buffer_load_dwordx4 v136, s[16:19], s60 offen sc1 lds
    s_add_u32 m0, s50, 4096
    s_nop 0
    buffer_load_dwordx4 v137, s[16:19], s60 offen sc1 lds
    s_add_u32 m0, s50, 8192
    s_nop 0
    buffer_load_dwordx4 v138, s[16:19], s60 offen sc1 lds
    s_add_u32 m0, s50, 12288
    s_nop 0
    buffer_load_dwordx4 v139, s[16:19], s60 offen sc1 lds
m_kernel_pad9:
    s_cbranch_execz m_kernel_pad10
    s_add_u32 s65, s65, 1
    s_add_u32 s50, s50, 24576
    s_cmp_ge_u32 s50, 155648
    s_cselect_b32 s51, 147456, 0
    s_sub_u32 s50, s50, s51
    s_xor_b32 s61, s65, s68
    s_lshl_b32 s60, s61, 14
    s_add_u32 s60, s60, s62
    s_lshl_b32 s61, s61, 17
    s_add_u32 m0, s50, 16384
    s_nop 0
    buffer_load_dwordx4 v132, s[20:23], s61 offen  lds
    s_add_u32 m0, s50, 20480
    s_nop 0
    buffer_load_dwordx4 v133, s[20:23], s61 offen  lds
    s_add_u32 m0, s50, 0
    s_nop 0
    buffer_load_dwordx4 v136, s[16:19], s60 offen sc1 lds
    s_add_u32 m0, s50, 4096
    s_nop 0
    buffer_load_dwordx4 v137, s[16:19], s60 offen sc1 lds
    s_add_u32 m0, s50, 8192
    s_nop 0
    buffer_load_dwordx4 v138, s[16:19], s60 offen sc1 lds
    s_add_u32 m0, s50, 12288
    s_nop 0
    buffer_load_dwordx4 v139, s[16:19], s60 offen sc1 lds
    s_add_u32 s65, s65, 1
    s_add_u32 s50, s50, 24576
    s_cmp_ge_u32 s50, 155648
    s_cselect_b32 s51, 147456, 0
    s_sub_u32 s50, s50, s51
    s_waitcnt vmcnt(30)
    s_barrier
    s_mov_b32 s52, 1
m_kernel_lb1:
    s_waitcnt vmcnt(24)
    s_barrier
    s_xor_b32 s61, s65, s68
    s_lshl_b32 s60, s61, 14
    s_add_u32 s60, s60, s62
    s_lshl_b32 s61, s61, 17
    s_add_u32 m0, s50, 16384
    s_nop 0
    buffer_load_dwordx4 v132, s[20:23], s61 offen  lds
    s_add_u32 m0, s50, 20480
    s_nop 0
    buffer_load_dwordx4 v133, s[20:23], s61 offen  lds
    s_add_u32 m0, s50, 0
    s_nop 0
    buffer_load_dwordx4 v136, s[16:19], s60 offen sc1 lds
    s_add_u32 m0, s50, 4096
    s_nop 0
    buffer_load_dwordx4 v137, s[16:19], s60 offen sc1 lds
    s_add_u32 m0, s50, 8192
    s_nop 0
    buffer_load_dwordx4 v138, s[16:19], s60 offen sc1 lds
    s_add_u32 m0, s50, 12288
    s_nop 0
    buffer_load_dwordx4 v139, s[16:19], s60 offen sc1 lds
    s_add_u32 s65, s65, 1
    s_add_u32 s50, s50, 24576
    s_cmp_ge_u32 s50, 155648
    s_cselect_b32 s51, 147456, 0
    s_sub_u32 s50, s50, s51
    s_add_u32 s52, s52, 1
    s_cmp_lt_u32 s52, 4
    s_cbranch_scc1 m_kernel_lb1
    s_waitcnt vmcnt(24)
    s_barrier
    s_waitcnt vmcnt(18)
    s_barrier
    s_waitcnt vmcnt(12)
    s_barrier
    s_waitcnt vmcnt(6)
    s_barrier
    s_mov_b32 s20, s12
    s_mov_b32 s21, s13
    s_mov_b32 s22, 7340032
    s_mov_b32 s65, 0
    s_mul_i32 s62, s36, 917504
    s_add_u32 s62, s62, 0x1680000
    s_and_b32 s40, s36, 7
    s_mul_i32 s40, s40, 4
    s_lshr_b32 s40, s40, 3
    s_and_b32 s41, s37, 3
    s_mul_i32 s41, s41, 4
    s_lshr_b32 s41, s41, 2
    s_add_u32 s40, s40, s41
    s_and_b32 s68, s40, 3
    s_movk_i32 s41, 0x4000
m_kernel_sg:
    s_mov_b32 s40, 0x2704000
    buffer_load_dword v20, v135, s[16:19], s40 offen sc1
    s_waitcnt vmcnt(0)
    v_cmp_ne_u32 vcc, s5, v20
    s_nop 1
    s_cmp_eq_u64 vcc, 0
    s_cbranch_scc1 m_kernel_sgd
    s_sub_u32 s41, s41, 1
    s_cbranch_scc0 m_kernel_sg
m_kernel_sgd:
    s_mov_b32 s52, 0
m_kernel_lb2:
    s_xor_b32 s61, s65, s68
    s_lshl_b32 s60, s61, 14
    s_add_u32 s60, s60, s62
    s_lshl_b32 s61, s61, 17
    s_add_u32 m0, s50, 16384
    s_nop 0
    buffer_load_dwordx4 v132, s[20:23], s61 offen  lds
    s_add_u32 m0, s50, 20480
    s_nop 0
    buffer_load_dwordx4 v133, s[20:23], s61 offen  lds
    s_add_u32 m0, s50, 0
    s_nop 0
    buffer_load_dwordx4 v128, s[16:19], s60 offen sc1 lds
    s_add_u32 m0, s50, 4096
    s_nop 0
    buffer_load_dwordx4 v129, s[16:19], s60 offen sc1 lds
    s_add_u32 m0, s50, 8192
    s_nop 0
    buffer_load_dwordx4 v130, s[16:19], s60 offen sc1 lds
    s_add_u32 m0, s50, 12288
    s_nop 0
    buffer_load_dwordx4 v131, s[16:19], s60 offen sc1 lds
    s_add_u32 s65, s65, 1
    s_add_u32 s50, s50, 24576
    s_cmp_ge_u32 s50, 155648
    s_cselect_b32 s51, 147456, 0
    s_sub_u32 s50, s50, s51
    s_add_u32 s52, s52, 1
    s_cmp_lt_u32 s52, 4
    s_cbranch_scc1 m_kernel_lb2
    s_mov_b32 s52, 8
m_kernel_lb3:
    s_waitcnt vmcnt(24)
    s_barrier
    s_xor_b32 s61, s65, s68
    s_lshl_b32 s60, s61, 14
    s_add_u32 s60, s60, s62
    s_lshl_b32 s61, s61, 17
    s_add_u32 m0, s50, 16384
    s_nop 0
    buffer_load_dwordx4 v132, s[20:23], s61 offen  lds
    s_add_u32 m0, s50, 20480
    s_nop 0
    buffer_load_dwordx4 v133, s[20:23], s61 offen  lds
    s_add_u32 m0, s50, 0
    s_nop 0
    buffer_load_dwordx4 v128, s[16:19], s60 offen sc1 lds
    s_add_u32 m0, s50, 4096
    s_nop 0
    buffer_load_dwordx4 v129, s[16:19], s60 offen sc1 lds
    s_add_u32 m0, s50, 8192
    s_nop 0
    buffer_load_dwordx4 v130, s[16:19], s60 offen sc1 lds
    s_add_u32 m0, s50, 12288
    s_nop 0
    buffer_load_dwordx4 v131, s[16:19], s60 offen sc1 lds
    s_add_u32 s65, s65, 1
    s_add_u32 s50, s50, 24576
    s_cmp_ge_u32 s50, 155648
    s_cselect_b32 s51, 147456, 0
    s_sub_u32 s50, s50, s51
    s_add_u32 s52, s52, 1
    s_cmp_lt_u32 s52, 60
    s_cbranch_scc1 m_kernel_lb3
    s_waitcnt vmcnt(24)
    s_barrier
    s_waitcnt vmcnt(18)
    s_barrier
    s_waitcnt vmcnt(12)
    s_barrier
    s_waitcnt vmcnt(6)
    s_barrier
    s_waitcnt vmcnt(0)
    s_barrier
    s_barrier
    s_or_b32 s40, s2, s4
    s_cbranch_scc1 m_kernel_ne
    s_mov_b32 s34, 0x2700000
    s_add_u32 s40, s34, 20480
    s_mov_b64 exec, 1
    v_mov_b32 v2, s5
    buffer_store_dword v2, off, s[16:19], s40 sc1
    s_mov_b64 exec, -1
m_kernel_ne:
    s_endpgm
m_kernel_cons2:
    s_mov_b32 s24, s10
    s_mov_b32 s25, s11
    s_mov_b32 s26, 0x400000
    s_mov_b32 s27, 0x20000
    v_and_b32 v2, 15, v1
    v_add_u32 v2, s48, v2
    v_lshlrev_b32 v2, 4, v2
    v_add_u32 v2, 155648, v2
    ds_read_b64 v[64:65], v2 offset:256
    ds_read_b64 v[66:67], v2 offset:512
    v_and_b32 v2, 15, v1
    v_add_u32 v2, s48, v2
    v_lshrrev_b32 v3, 4, v1
    v_lshlrev_b32 v3, 11, v3
    v_lshl_add_u32 v2, v2, 4, v3
    v_add_u32 v6, 81920, v2
    v_add_u32 v7, 90112, v2
m_kernel_pad10:
    s_cbranch_execz m_kernel_wret
    v_lshrrev_b32 v2, 4, v1
    v_bfe_u32 v3, v1, 2, 2
    v_lshl_add_u32 v4, v2, 3, v3
    v_lshlrev_b32 v4, 7, v4
    v_bfe_u32 v5, v1, 3, 2
    v_lshl_add_u32 v4, v5, 5, v4
    v_and_b32 v3, 3, v1
    v_lshl_add_u32 v4, v3, 3, v4
    v_add_u32 v8, 98304, v4
    v_xor_b32 v9, 32, v8
    v_xor_b32 v10, 64, v8
    v_xor_b32 v11, 96, v8
    v_and_b32 v2, 15, v1
    v_add_u32 v2, s48, v2
    v_bfe_u32 v3, v1, 4, 1
    v_lshrrev_b32 v4, 5, v1
    v_lshl_add_u32 v3, v3, 1, v4
    v_lshlrev_b32 v3, 11, v3
    v_lshl_add_u32 v2, v2, 4, v3
    v_add_u32 v250, s32, v2
    v_add_u32 v251, 8192, v250
    s_waitcnt vmcnt(2) lgkmcnt(0)
    v_mul_f32 v64, v64, v65
    v_mul_f32 v66, v66, v67
    v_permlane16_swap_b32 v200, v202
    v_permlane16_swap_b32 v201, v203
    s_nop 1
    v_lshlrev_b32 v216, 16, v200
    v_and_b32 v217, 0xffff0000, v200
    v_lshlrev_b32 v218, 16, v201
    v_and_b32 v219, 0xffff0000, v201
    v_lshlrev_b32 v220, 16, v202
    v_and_b32 v221, 0xffff0000, v202
    v_lshlrev_b32 v222, 16, v203
    v_and_b32 v223, 0xffff0000, v203
    v_pk_fma_f32 v[216:217], v[216:217], v[64:65], v[64:65] op_sel:[0,1,0] op_sel_hi:[1,1,0]
    v_pk_fma_f32 v[218:219], v[218:219], v[64:65], v[64:65] op_sel:[0,1,0] op_sel_hi:[1,1,0]
    v_pk_fma_f32 v[220:221], v[220:221], v[64:65], v[64:65] op_sel:[0,1,0] op_sel_hi:[1,1,0]
    v_pk_fma_f32 v[222:223], v[222:223], v[64:65], v[64:65] op_sel:[0,1,0] op_sel_hi:[1,1,0]
    v_permlane16_swap_b32 v204, v206
    v_permlane16_swap_b32 v205, v207
    s_nop 1
    v_lshlrev_b32 v224, 16, v204
    v_and_b32 v225, 0xffff0000, v204
    v_lshlrev_b32 v226, 16, v205
    v_and_b32 v227, 0xffff0000, v205
    v_lshlrev_b32 v228, 16, v206
    v_and_b32 v229, 0xffff0000, v206
    v_lshlrev_b32 v230, 16, v207
    v_and_b32 v231, 0xffff0000, v207
    v_pk_fma_f32 v[224:225], v[224:225], v[64:65], v[64:65] op_sel:[0,1,0] op_sel_hi:[1,1,0]
    v_pk_fma_f32 v[226:227], v[226:227], v[64:65], v[64:65] op_sel:[0,1,0] op_sel_hi:[1,1,0]
    v_pk_fma_f32 v[228:229], v[228:229], v[64:65], v[64:65] op_sel:[0,1,0] op_sel_hi:[1,1,0]
    v_pk_fma_f32 v[230:231], v[230:231], v[64:65], v[64:65] op_sel:[0,1,0] op_sel_hi:[1,1,0]
    v_permlane16_swap_b32 v208, v210
    v_permlane16_swap_b32 v209, v211
    s_nop 1
    v_lshlrev_b32 v232, 16, v208
    v_and_b32 v233, 0xffff0000, v208
    v_lshlrev_b32 v234, 16, v209
    v_and_b32 v235, 0xffff0000, v209
    v_lshlrev_b32 v236, 16, v210
    v_and_b32 v237, 0xffff0000, v210
    v_lshlrev_b32 v238, 16, v211
    v_and_b32 v239, 0xffff0000, v211
    v_pk_fma_f32 v[232:233], v[232:233], v[66:67], v[66:67] op_sel:[0,1,0] op_sel_hi:[1,1,0]
    v_pk_fma_f32 v[234:235], v[234:235], v[66:67], v[66:67] op_sel:[0,1,0] op_sel_hi:[1,1,0]
    v_pk_fma_f32 v[236:237], v[236:237], v[66:67], v[66:67] op_sel:[0,1,0] op_sel_hi:[1,1,0]
    v_pk_fma_f32 v[238:239], v[238:239], v[66:67], v[66:67] op_sel:[0,1,0] op_sel_hi:[1,1,0]
    v_permlane16_swap_b32 v212, v214
    v_permlane16_swap_b32 v213, v215
    s_nop 1
    v_lshlrev_b32 v240, 16, v212
    v_and_b32 v241, 0xffff0000, v212
    v_lshlrev_b32 v242, 16, v213
    v_and_b32 v243, 0xffff0000, v213
    v_lshlrev_b32 v244, 16, v214
    v_and_b32 v245, 0xffff0000, v214
    v_lshlrev_b32 v246, 16, v215
    v_and_b32 v247, 0xffff0000, v215
    v_pk_fma_f32 v[240:241], v[240:241], v[66:67], v[66:67] op_sel:[0,1,0] op_sel_hi:[1,1,0]
    v_pk_fma_f32 v[242:243], v[242:243], v[66:67], v[66:67] op_sel:[0,1,0] op_sel_hi:[1,1,0]
    v_pk_fma_f32 v[244:245], v[244:245], v[66:67], v[66:67] op_sel:[0,1,0] op_sel_hi:[1,1,0]
    v_pk_fma_f32 v[246:247], v[246:247], v[66:67], v[66:67] op_sel:[0,1,0] op_sel_hi:[1,1,0]
    s_waitcnt vmcnt(0)
    s_add_u32 s40, s34, s33
    s_mov_b64 exec, 1
    v_mov_b32 v2, s5
    buffer_store_dword v2, off, s[16:19], s40 sc1
    s_mov_b64 exec, -1
    s_mov_b32 s52, 0
    s_mov_b32 s50, 73728
    s_mov_b32 s53, 24576
    s_mov_b64 exec, 0
    s_lshr_b32 s40, s2, 3
    s_mov_b32 s41, -1
m_kernel_wret2:
    s_add_u32 s41, s41, 1
    s_cmp_ge_u32 s41, 1
    s_cbranch_scc1 m_kernel_wend2
    s_add_u32 s42, s40, s41
    s_and_b32 s42, s42, 3
    s_lshl2_add_u32 s42, s42, s4
    s_cmp_eq_u32 s42, 0
    s_cbranch_scc1 m_kernel_padb0
    s_cmp_eq_u32 s42, 1
    s_cbranch_scc1 m_kernel_padb2
    s_cmp_eq_u32 s42, 2
    s_cbranch_scc1 m_kernel_padb4
    s_cmp_eq_u32 s42, 3
    s_cbranch_scc1 m_kernel_padb6
    s_cmp_eq_u32 s42, 4
    s_cbranch_scc1 m_kernel_padb8
    s_cmp_eq_u32 s42, 5
    s_cbranch_scc1 m_kernel_padb10
    s_cmp_eq_u32 s42, 6
    s_cbranch_scc1 m_kernel_padb12
    s_cmp_eq_u32 s42, 7
    s_cbranch_scc1 m_kernel_padb14
    s_cmp_eq_u32 s42, 8
    s_cbranch_scc1 m_kernel_padb16
    s_cmp_eq_u32 s42, 9
    s_cbranch_scc1 m_kernel_padb18
    s_cmp_eq_u32 s42, 10
    s_cbranch_scc1 m_kernel_padb20
    s_cmp_eq_u32 s42, 11
    s_cbranch_scc1 m_kernel_padb22
    s_cmp_eq_u32 s42, 12
    s_cbranch_scc1 m_kernel_padb24
    s_cmp_eq_u32 s42, 13
    s_cbranch_scc1 m_kernel_padb26
    s_branch m_kernel_wret2
m_kernel_wend2:
    s_mov_b64 exec, -1
    s_barrier
    ds_read_b128 v[16:19], v6 offset:0
    ds_read_b64_tr_b16 v[24:25], v8 offset:0
    ds_read_b64_tr_b16 v[26:27], v8 offset:512
    ds_read_b64_tr_b16 v[28:29], v9 offset:0
    ds_read_b64_tr_b16 v[30:31], v9 offset:512
    ds_read_b64_tr_b16 v[32:33], v10 offset:0
    ds_read_b64_tr_b16 v[34:35], v10 offset:512
    ds_read_b64_tr_b16 v[36:37], v11 offset:0
    ds_read_b64_tr_b16 v[38:39], v11 offset:512
    ds_read_b128 v[20:23], v6 offset:256
    .p2align 4
m_kernel_c2:
    s_waitcnt lgkmcnt(0)
    v_mfma_f32_16x16x32_bf16 v[216:219], v[24:27], v[16:19], v[216:219]
    ds_read_b128 v[40:43], v7 offset:0
    ds_read_b64_tr_b16 v[48:49], v8 offset:4096
    v_mfma_f32_16x16x32_bf16 v[232:235], v[24:27], v[20:23], v[232:235]
    ds_read_b64_tr_b16 v[50:51], v8 offset:4608
    ds_read_b64_tr_b16 v[52:53], v9 offset:4096
    v_mfma_f32_16x16x32_bf16 v[220:223], v[28:31], v[16:19], v[220:223]
    ds_read_b64_tr_b16 v[54:55], v9 offset:4608
    ds_read_b64_tr_b16 v[56:57], v10 offset:4096
    v_mfma_f32_16x16x32_bf16 v[236:239], v[28:31], v[20:23], v[236:239]
    ds_read_b64_tr_b16 v[58:59], v10 offset:4608
    ds_read_b64_tr_b16 v[60:61], v11 offset:4096
    v_mfma_f32_16x16x32_bf16 v[224:227], v[32:35], v[16:19], v[224:227]
    ds_read_b64_tr_b16 v[62:63], v11 offset:4608
    ds_read_b128 v[44:47], v7 offset:256
    v_mfma_f32_16x16x32_bf16 v[240:243], v[32:35], v[20:23], v[240:243]
    s_add_u32 s50, s50, 24576
    s_cmp_ge_u32 s50, 147456
    v_mfma_f32_16x16x32_bf16 v[228:231], v[36:39], v[16:19], v[228:231]
    s_cselect_b32 s51, 0xfffe2000, s53
    s_cselect_b32 s50, 0, s50
    v_mfma_f32_16x16x32_bf16 v[244:247], v[36:39], v[20:23], v[244:247]
    v_add_u32 v6, s51, v6
    s_waitcnt lgkmcnt(0)
    v_mfma_f32_16x16x32_bf16 v[216:219], v[48:51], v[40:43], v[216:219]
    s_barrier
    v_add_u32 v8, s51, v8
    v_add_u32 v9, s51, v9
    v_add_u32 v10, s51, v10
    v_add_u32 v11, s51, v11
    ds_read_b128 v[16:19], v6 offset:0
    v_mfma_f32_16x16x32_bf16 v[232:235], v[48:51], v[44:47], v[232:235]
    ds_read_b64_tr_b16 v[24:25], v8 offset:0
    ds_read_b64_tr_b16 v[26:27], v8 offset:512
    v_mfma_f32_16x16x32_bf16 v[220:223], v[52:55], v[40:43], v[220:223]
    ds_read_b64_tr_b16 v[28:29], v9 offset:0
    ds_read_b64_tr_b16 v[30:31], v9 offset:512
    v_mfma_f32_16x16x32_bf16 v[236:239], v[52:55], v[44:47], v[236:239]
    ds_read_b64_tr_b16 v[32:33], v10 offset:0
    ds_read_b64_tr_b16 v[34:35], v10 offset:512
    v_mfma_f32_16x16x32_bf16 v[224:227], v[56:59], v[40:43], v[224:227]
    ds_read_b64_tr_b16 v[36:37], v11 offset:0
    ds_read_b64_tr_b16 v[38:39], v11 offset:512
    v_mfma_f32_16x16x32_bf16 v[240:243], v[56:59], v[44:47], v[240:243]
    ds_read_b128 v[20:23], v6 offset:256
    v_add_u32 v7, s51, v7
    v_mfma_f32_16x16x32_bf16 v[228:231], v[60:63], v[40:43], v[228:231]
    s_add_u32 s52, s52, 1
    v_mfma_f32_16x16x32_bf16 v[244:247], v[60:63], v[44:47], v[244:247]
    s_cmp_lt_u32 s52, 16
    s_cbranch_scc1 m_kernel_c2
m_kernel_padb0:
    s_cbranch_execz m_kernel_padb1
    s_mov_b32 s44, 0xd80000
    s_nop 7
    s_nop 1
    v_cvt_pk_bf16_f32 v64, v216, v217
    v_cvt_pk_bf16_f32 v65, v218, v219
    v_cvt_pk_bf16_f32 v66, v220, v221
    v_cvt_pk_bf16_f32 v67, v222, v223
    s_nop 1
    v_permlane16_swap_b32 v64, v66
    v_permlane16_swap_b32 v65, v67
    buffer_store_dwordx4 v[64:67], v250, s[16:19], s44 offen offset:0 sc1
    v_cvt_pk_bf16_f32 v68, v224, v225
    v_cvt_pk_bf16_f32 v69, v226, v227
    v_cvt_pk_bf16_f32 v70, v228, v229
    v_cvt_pk_bf16_f32 v71, v230, v231
    s_nop 1
    v_permlane16_swap_b32 v68, v70
    v_permlane16_swap_b32 v69, v71
    buffer_store_dwordx4 v[68:71], v251, s[16:19], s44 offen offset:0 sc1
    v_cvt_pk_bf16_f32 v72, v232, v233
    v_cvt_pk_bf16_f32 v73, v234, v235
    v_cvt_pk_bf16_f32 v74, v236, v237
    v_cvt_pk_bf16_f32 v75, v238, v239
    s_nop 1
    v_permlane16_swap_b32 v72, v74
    v_permlane16_swap_b32 v73, v75
    buffer_store_dwordx4 v[72:75], v250, s[16:19], s44 offen offset:256 sc1
    v_cvt_pk_bf16_f32 v76, v240, v241
    v_cvt_pk_bf16_f32 v77, v242, v243
    v_cvt_pk_bf16_f32 v78, v244, v245
    v_cvt_pk_bf16_f32 v79, v246, v247
    s_nop 1
    v_permlane16_swap_b32 v76, v78
    v_permlane16_swap_b32 v77, v79
    buffer_store_dwordx4 v[76:79], v251, s[16:19], s44 offen offset:256 sc1
    v_pk_add_f32 v[80:81], v[216:217], v[218:219]
    v_pk_mul_f32 v[82:83], v[216:217], v[216:217]
    v_pk_fma_f32 v[82:83], v[218:219], v[218:219], v[82:83]
    v_pk_add_f32 v[80:81], v[80:81], v[220:221]
    v_pk_fma_f32 v[82:83], v[220:221], v[220:221], v[82:83]
    v_pk_add_f32 v[80:81], v[80:81], v[222:223]
    v_pk_fma_f32 v[82:83], v[222:223], v[222:223], v[82:83]
    v_pk_add_f32 v[80:81], v[80:81], v[224:225]
    v_pk_fma_f32 v[82:83], v[224:225], v[224:225], v[82:83]
    v_pk_add_f32 v[80:81], v[80:81], v[226:227]
m_kernel_padb1:
    s_cbranch_execz m_kernel_wret2
    v_pk_fma_f32 v[82:83], v[226:227], v[226:227], v[82:83]
    v_pk_add_f32 v[80:81], v[80:81], v[228:229]
    v_pk_fma_f32 v[82:83], v[228:229], v[228:229], v[82:83]
    v_pk_add_f32 v[80:81], v[80:81], v[230:231]
    v_pk_fma_f32 v[82:83], v[230:231], v[230:231], v[82:83]
    v_add_f32 v80, v80, v81
    v_add_f32 v81, v82, v83
    v_pk_add_f32 v[84:85], v[232:233], v[234:235]
    v_pk_mul_f32 v[86:87], v[232:233], v[232:233]
    v_pk_fma_f32 v[86:87], v[234:235], v[234:235], v[86:87]
    v_pk_add_f32 v[84:85], v[84:85], v[236:237]
    v_pk_fma_f32 v[86:87], v[236:237], v[236:237], v[86:87]
    v_pk_add_f32 v[84:85], v[84:85], v[238:239]
    v_pk_fma_f32 v[86:87], v[238:239], v[238:239], v[86:87]
    v_pk_add_f32 v[84:85], v[84:85], v[240:241]
    v_pk_fma_f32 v[86:87], v[240:241], v[240:241], v[86:87]
    v_pk_add_f32 v[84:85], v[84:85], v[242:243]
    v_pk_fma_f32 v[86:87], v[242:243], v[242:243], v[86:87]
    v_pk_add_f32 v[84:85], v[84:85], v[244:245]
    v_pk_fma_f32 v[86:87], v[244:245], v[244:245], v[86:87]
    v_pk_add_f32 v[84:85], v[84:85], v[246:247]
    v_pk_fma_f32 v[86:87], v[246:247], v[246:247], v[86:87]
    v_add_f32 v84, v84, v85
    v_add_f32 v85, v86, v87
    s_nop 1
    v_permlane16_swap_b32 v80, v84
    v_permlane16_swap_b32 v81, v85
    s_nop 1
    v_pk_add_f32 v[80:81], v[80:81], v[84:85]
    v_mov_b32 v84, v80
    v_mov_b32 v85, v81
    s_nop 1
    v_permlane32_swap_b32 v80, v84
    v_permlane32_swap_b32 v81, v85
    s_nop 1
    v_pk_add_f32 v[80:81], v[80:81], v[84:85]
    s_lshl_b32 s40, s37, 14
    s_lshl3_add_u32 s40, s47, s40
    s_add_u32 s40, s40, 0x2640000
    v_lshlrev_b32 v2, 3, v1
    s_mov_b64 exec, 0xffffffff
    buffer_store_dwordx2 v[80:81], v2, s[16:19], s40 offen sc1
    s_mov_b64 exec, -1
    s_mov_b32 s52, 0
    .p2align 4
m_kernel_c2a:
    s_waitcnt lgkmcnt(0)
    v_mfma_f32_16x16x32_bf16 v[216:219], v[24:27], v[16:19], v[216:219]
    ds_read_b128 v[40:43], v7 offset:0
    ds_read_b64_tr_b16 v[48:49], v8 offset:4096
    v_mfma_f32_16x16x32_bf16 v[232:235], v[24:27], v[20:23], v[232:235]
    ds_read_b64_tr_b16 v[50:51], v8 offset:4608
    ds_read_b64_tr_b16 v[52:53], v9 offset:4096
    v_mfma_f32_16x16x32_bf16 v[220:223], v[28:31], v[16:19], v[220:223]
    ds_read_b64_tr_b16 v[54:55], v9 offset:4608
    ds_read_b64_tr_b16 v[56:57], v10 offset:4096
    v_mfma_f32_16x16x32_bf16 v[236:239], v[28:31], v[20:23], v[236:239]
    ds_read_b64_tr_b16 v[58:59], v10 offset:4608
    ds_read_b64_tr_b16 v[60:61], v11 offset:4096
    v_mfma_f32_16x16x32_bf16 v[224:227], v[32:35], v[16:19], v[224:227]
    ds_read_b64_tr_b16 v[62:63], v11 offset:4608
    ds_read_b128 v[44:47], v7 offset:256
    v_mfma_f32_16x16x32_bf16 v[240:243], v[32:35], v[20:23], v[240:243]
    s_add_u32 s50, s50, 24576
    s_cmp_ge_u32 s50, 147456
    v_mfma_f32_16x16x32_bf16 v[228:231], v[36:39], v[16:19], v[228:231]
    s_cselect_b32 s51, 0xfffe2000, s53
    s_cselect_b32 s50, 0, s50
    v_mfma_f32_16x16x32_bf16 v[244:247], v[36:39], v[20:23], v[244:247]
    v_add_u32 v6, s51, v6
    s_waitcnt lgkmcnt(0)
    v_mfma_f32_16x16x32_bf16 v[216:219], v[48:51], v[40:43], v[216:219]
    s_barrier
    v_add_u32 v8, s51, v8
    v_add_u32 v9, s51, v9
    v_add_u32 v10, s51, v10
    v_add_u32 v11, s51, v11
    ds_read_b128 v[16:19], v6 offset:0
    v_mfma_f32_16x16x32_bf16 v[232:235], v[48:51], v[44:47], v[232:235]
    ds_read_b64_tr_b16 v[24:25], v8 offset:0
    ds_read_b64_tr_b16 v[26:27], v8 offset:512
    v_mfma_f32_16x16x32_bf16 v[220:223], v[52:55], v[40:43], v[220:223]
    ds_read_b64_tr_b16 v[28:29], v9 offset:0
    ds_read_b64_tr_b16 v[30:31], v9 offset:512
    v_mfma_f32_16x16x32_bf16 v[236:239], v[52:55], v[44:47], v[236:239]
    ds_read_b64_tr_b16 v[32:33], v10 offset:0
    ds_read_b64_tr_b16 v[34:35], v10 offset:512
    v_mfma_f32_16x16x32_bf16 v[224:227], v[56:59], v[40:43], v[224:227]
    ds_read_b64_tr_b16 v[36:37], v11 offset:0
    ds_read_b64_tr_b16 v[38:39], v11 offset:512
    v_mfma_f32_16x16x32_bf16 v[240:243], v[56:59], v[44:47], v[240:243]
    ds_read_b128 v[20:23], v6 offset:256
    v_add_u32 v7, s51, v7
    v_mfma_f32_16x16x32_bf16 v[228:231], v[60:63], v[40:43], v[228:231]
    s_add_u32 s52, s52, 1
    v_mfma_f32_16x16x32_bf16 v[244:247], v[60:63], v[44:47], v[244:247]
    s_cmp_lt_u32 s52, 3
    s_cbranch_scc1 m_kernel_c2a
m_kernel_padb2:
    s_cbranch_execz m_kernel_padb3
    s_waitcnt vmcnt(0)
    s_add_u32 s40, s34, 12288
    s_mov_b64 exec, 1
    v_mov_b32 v2, s5
    buffer_store_dword v2, off, s[16:19], s40 sc1
    s_mov_b64 exec, -1
    s_mov_b32 s52, 0
    .p2align 4
m_kernel_c2b:
    s_waitcnt lgkmcnt(0)
    v_mfma_f32_16x16x32_bf16 v[216:219], v[24:27], v[16:19], v[216:219]
    ds_read_b128 v[40:43], v7 offset:0
    ds_read_b64_tr_b16 v[48:49], v8 offset:4096
    v_mfma_f32_16x16x32_bf16 v[232:235], v[24:27], v[20:23], v[232:235]
    ds_read_b64_tr_b16 v[50:51], v8 offset:4608
    ds_read_b64_tr_b16 v[52:53], v9 offset:4096
    v_mfma_f32_16x16x32_bf16 v[220:223], v[28:31], v[16:19], v[220:223]
    ds_read_b64_tr_b16 v[54:55], v9 offset:4608
    ds_read_b64_tr_b16 v[56:57], v10 offset:4096
    v_mfma_f32_16x16x32_bf16 v[236:239], v[28:31], v[20:23], v[236:239]
    ds_read_b64_tr_b16 v[58:59], v10 offset:4608
    ds_read_b64_tr_b16 v[60:61], v11 offset:4096
    v_mfma_f32_16x16x32_bf16 v[224:227], v[32:35], v[16:19], v[224:227]
    ds_read_b64_tr_b16 v[62:63], v11 offset:4608
    ds_read_b128 v[44:47], v7 offset:256
    v_mfma_f32_16x16x32_bf16 v[240:243], v[32:35], v[20:23], v[240:243]
    s_add_u32 s50, s50, 24576
    s_cmp_ge_u32 s50, 147456
    v_mfma_f32_16x16x32_bf16 v[228:231], v[36:39], v[16:19], v[228:231]
    s_cselect_b32 s51, 0xfffe2000, s53
    s_cselect_b32 s50, 0, s50
    v_mfma_f32_16x16x32_bf16 v[244:247], v[36:39], v[20:23], v[244:247]
    v_add_u32 v6, s51, v6
    s_waitcnt lgkmcnt(0)
    v_mfma_f32_16x16x32_bf16 v[216:219], v[48:51], v[40:43], v[216:219]
    s_barrier
    v_add_u32 v8, s51, v8
    v_add_u32 v9, s51, v9
    v_add_u32 v10, s51, v10
    v_add_u32 v11, s51, v11
    ds_read_b128 v[16:19], v6 offset:0
    v_mfma_f32_16x16x32_bf16 v[232:235], v[48:51], v[44:47], v[232:235]
    ds_read_b64_tr_b16 v[24:25], v8 offset:0
    ds_read_b64_tr_b16 v[26:27], v8 offset:512
    v_mfma_f32_16x16x32_bf16 v[220:223], v[52:55], v[40:43], v[220:223]
    ds_read_b64_tr_b16 v[28:29], v9 offset:0
    ds_read_b64_tr_b16 v[30:31], v9 offset:512
    v_mfma_f32_16x16x32_bf16 v[236:239], v[52:55], v[44:47], v[236:239]
    ds_read_b64_tr_b16 v[32:33], v10 offset:0
    ds_read_b64_tr_b16 v[34:35], v10 offset:512
    v_mfma_f32_16x16x32_bf16 v[224:227], v[56:59], v[40:43], v[224:227]
    ds_read_b64_tr_b16 v[36:37], v11 offset:0
    ds_read_b64_tr_b16 v[38:39], v11 offset:512
    v_mfma_f32_16x16x32_bf16 v[240:243], v[56:59], v[44:47], v[240:243]
    ds_read_b128 v[20:23], v6 offset:256
    v_add_u32 v7, s51, v7
    v_mfma_f32_16x16x32_bf16 v[228:231], v[60:63], v[40:43], v[228:231]
    s_add_u32 s52, s52, 1
    v_mfma_f32_16x16x32_bf16 v[244:247], v[60:63], v[44:47], v[244:247]
    s_cmp_lt_u32 s52, 4
    s_cbranch_scc1 m_kernel_c2b
m_kernel_padb3:
    s_cbranch_execz m_kernel_wret2
    s_and_b32 s46, s4, 1
    s_lshl_b32 s46, s46, 6
    s_add_u32 s45, s38, s46
    s_lshr_b32 s33, s4, 1
    s_lshl_b32 s49, s33, 8
    s_waitcnt lgkmcnt(0)
    v_and_b32 v2, 15, v1
    v_add_u32 v2, s46, v2
    v_lshrrev_b32 v3, 4, v1
    v_lshlrev_b32 v3, 11, v3
    v_lshl_add_u32 v2, v2, 4, v3
    v_add_u32 v6, 57344, v2
    v_add_u32 v7, 65536, v2
    v_lshrrev_b32 v2, 4, v1
    v_bfe_u32 v3, v1, 2, 2
    v_lshl_add_u32 v4, v2, 3, v3
    v_mul_u32_u24 v4, 448, v4
    v_and_b32 v3, 3, v1
    v_lshl_add_u32 v4, v3, 3, v4
    v_add_u32 v4, 73728, v4
    v_and_b32 v2, 1, v2
    v_lshlrev_b32 v2, 5, v2
    v_add3_u32 v8, v4, v2, s49
    v_sub_u32 v9, v4, v2
    v_add_u32 v9, s49, v9
    s_lshl_b32 s40, s33, 5
    v_xor_b32 v2, s40, v2
    v_add3_u32 v10, v4, v2, 0
    v_add_u32 v10, 192, v10
    v_mov_b32 v104, 0
    v_mov_b32 v105, 0
    v_mov_b32 v106, 0
    v_mov_b32 v107, 0
    v_mov_b32 v108, 0
    v_mov_b32 v109, 0
    v_mov_b32 v110, 0
    v_mov_b32 v111, 0
    v_mov_b32 v112, 0
    v_mov_b32 v113, 0
    v_mov_b32 v114, 0
    v_mov_b32 v115, 0
    v_mov_b32 v116, 0
    v_mov_b32 v117, 0
    v_mov_b32 v118, 0
    v_mov_b32 v119, 0
    v_mov_b32 v120, 0
    v_mov_b32 v121, 0
    v_mov_b32 v122, 0
    v_mov_b32 v123, 0
    v_mov_b32 v124, 0
    v_mov_b32 v125, 0
    v_mov_b32 v126, 0
    v_mov_b32 v127, 0
    v_mov_b32 v128, 0
    v_mov_b32 v129, 0
    v_mov_b32 v130, 0
    v_mov_b32 v131, 0
    v_mov_b32 v132, 0
    v_mov_b32 v133, 0
    v_mov_b32 v134, 0
    v_mov_b32 v135, 0
    v_mov_b32 v136, 0
    v_mov_b32 v137, 0
    v_mov_b32 v138, 0
m_kernel_padb4:
    s_cbranch_execz m_kernel_padb5
    v_mov_b32 v139, 0
    v_mov_b32 v140, 0
    v_mov_b32 v141, 0
    v_mov_b32 v142, 0
    v_mov_b32 v143, 0
    v_mov_b32 v144, 0
    v_mov_b32 v145, 0
    v_mov_b32 v146, 0
    v_mov_b32 v147, 0
    v_mov_b32 v148, 0
    v_mov_b32 v149, 0
    v_mov_b32 v150, 0
    v_mov_b32 v151, 0
    v_mov_b32 v152, 0
    v_mov_b32 v153, 0
    v_mov_b32 v154, 0
    v_mov_b32 v155, 0
    v_mov_b32 v156, 0
    v_mov_b32 v157, 0
    v_mov_b32 v158, 0
    v_mov_b32 v159, 0
    v_mov_b32 v160, 0
    v_mov_b32 v161, 0
    v_mov_b32 v162, 0
    v_mov_b32 v163, 0
    v_mov_b32 v164, 0
    v_mov_b32 v165, 0
    v_mov_b32 v166, 0
    v_mov_b32 v167, 0
    v_mov_b32 v168, 0
    v_mov_b32 v169, 0
    v_mov_b32 v170, 0
    v_mov_b32 v171, 0
    v_mov_b32 v172, 0
    v_mov_b32 v173, 0
    v_mov_b32 v174, 0
    v_mov_b32 v175, 0
    v_mov_b32 v176, 0
    v_mov_b32 v177, 0
    v_mov_b32 v178, 0
    v_mov_b32 v179, 0
    v_mov_b32 v180, 0
    v_mov_b32 v181, 0
    v_mov_b32 v182, 0
    v_mov_b32 v183, 0
    v_mov_b32 v184, 0
    v_mov_b32 v185, 0
    v_mov_b32 v186, 0
    v_mov_b32 v187, 0
    v_mov_b32 v188, 0
    v_mov_b32 v189, 0
    v_mov_b32 v190, 0
    v_mov_b32 v191, 0
    v_mov_b32 v192, 0
    v_mov_b32 v193, 0
    v_mov_b32 v194, 0
    v_mov_b32 v195, 0
    v_mov_b32 v196, 0
    v_mov_b32 v197, 0
    v_mov_b32 v198, 0
    v_mov_b32 v199, 0
    v_mov_b32 v200, 0
    v_mov_b32 v201, 0
    v_mov_b32 v202, 0
    v_mov_b32 v203, 0
    v_mov_b32 v204, 0
    v_mov_b32 v205, 0
    v_mov_b32 v206, 0
    v_mov_b32 v207, 0
    v_mov_b32 v208, 0
    v_mov_b32 v209, 0
    v_mov_b32 v210, 0
    v_mov_b32 v211, 0
    v_mov_b32 v212, 0
    v_mov_b32 v213, 0
m_kernel_padb5:
    s_cbranch_execz m_kernel_wret2
    v_mov_b32 v214, 0
    v_mov_b32 v215, 0
    s_mov_b32 s52, 0
    s_mov_b32 s50, 49152
    s_mov_b32 s53, 49152
    s_barrier
    ds_read_b128 v[16:19], v6 offset:0
    ds_read_b64_tr_b16 v[32:33], v8 offset:0
    ds_read_b64_tr_b16 v[34:35], v8 offset:1792
    ds_read_b64_tr_b16 v[36:37], v9 offset:32
    ds_read_b64_tr_b16 v[38:39], v9 offset:1824
    ds_read_b64_tr_b16 v[40:41], v8 offset:64
    ds_read_b64_tr_b16 v[42:43], v8 offset:1856
    ds_read_b64_tr_b16 v[44:45], v9 offset:96
    ds_read_b64_tr_b16 v[46:47], v9 offset:1888
    ds_read_b64_tr_b16 v[48:49], v8 offset:128
    ds_read_b64_tr_b16 v[50:51], v8 offset:1920
    ds_read_b64_tr_b16 v[52:53], v9 offset:160
    ds_read_b64_tr_b16 v[54:55], v9 offset:1952
    ds_read_b64_tr_b16 v[56:57], v10 offset:0
    ds_read_b64_tr_b16 v[58:59], v10 offset:1792
    ds_read_b128 v[20:23], v6 offset:256
    ds_read_b128 v[24:27], v6 offset:512
    ds_read_b128 v[28:31], v6 offset:768
    .p2align 4
m_kernel_c3:
    s_waitcnt lgkmcnt(0)
    v_mfma_f32_16x16x32_bf16 v[104:107], v[32:35], v[16:19], v[104:107]
    ds_read_b128 v[60:63], v7 offset:0
    v_mfma_f32_16x16x32_bf16 v[108:111], v[36:39], v[16:19], v[108:111]
    ds_read_b64_tr_b16 v[76:77], v8 offset:14336
    v_mfma_f32_16x16x32_bf16 v[112:115], v[40:43], v[16:19], v[112:115]
    ds_read_b64_tr_b16 v[78:79], v8 offset:16128
    v_mfma_f32_16x16x32_bf16 v[116:119], v[44:47], v[16:19], v[116:119]
    ds_read_b64_tr_b16 v[80:81], v9 offset:14368
    v_mfma_f32_16x16x32_bf16 v[120:123], v[48:51], v[16:19], v[120:123]
    ds_read_b64_tr_b16 v[82:83], v9 offset:16160
    v_mfma_f32_16x16x32_bf16 v[124:127], v[52:55], v[16:19], v[124:127]
    ds_read_b64_tr_b16 v[84:85], v8 offset:14400
    v_mfma_f32_16x16x32_bf16 v[128:131], v[56:59], v[16:19], v[128:131]
    ds_read_b64_tr_b16 v[86:87], v8 offset:16192
    v_mfma_f32_16x16x32_bf16 v[132:135], v[32:35], v[20:23], v[132:135]
    ds_read_b64_tr_b16 v[88:89], v9 offset:14432
    v_mfma_f32_16x16x32_bf16 v[136:139], v[36:39], v[20:23], v[136:139]
    ds_read_b64_tr_b16 v[90:91], v9 offset:16224
    v_mfma_f32_16x16x32_bf16 v[140:143], v[40:43], v[20:23], v[140:143]
    ds_read_b64_tr_b16 v[92:93], v8 offset:14464
    v_mfma_f32_16x16x32_bf16 v[144:147], v[44:47], v[20:23], v[144:147]
    ds_read_b64_tr_b16 v[94:95], v8 offset:16256
    v_mfma_f32_16x16x32_bf16 v[148:151], v[48:51], v[20:23], v[148:151]
    ds_read_b64_tr_b16 v[96:97], v9 offset:14496
    v_mfma_f32_16x16x32_bf16 v[152:155], v[52:55], v[20:23], v[152:155]
    ds_read_b64_tr_b16 v[98:99], v9 offset:16288
    v_mfma_f32_16x16x32_bf16 v[156:159], v[56:59], v[20:23], v[156:159]
    ds_read_b64_tr_b16 v[100:101], v10 offset:14336
    v_mfma_f32_16x16x32_bf16 v[160:163], v[32:35], v[24:27], v[160:163]
    ds_read_b64_tr_b16 v[102:103], v10 offset:16128
    v_mfma_f32_16x16x32_bf16 v[164:167], v[36:39], v[24:27], v[164:167]
    ds_read_b128 v[64:67], v7 offset:256
    v_mfma_f32_16x16x32_bf16 v[168:171], v[40:43], v[24:27], v[168:171]
    ds_read_b128 v[68:71], v7 offset:512
    v_mfma_f32_16x16x32_bf16 v[172:175], v[44:47], v[24:27], v[172:175]
    ds_read_b128 v[72:75], v7 offset:768
    v_mfma_f32_16x16x32_bf16 v[176:179], v[48:51], v[24:27], v[176:179]
    s_add_u32 s50, s50, 49152
    s_cmp_ge_u32 s50, 147456
    v_mfma_f32_16x16x32_bf16 v[180:183], v[52:55], v[24:27], v[180:183]
    s_cselect_b32 s51, 0xfffe8000, s53
    s_cselect_b32 s50, 0, s50
    v_mfma_f32_16x16x32_bf16 v[184:187], v[56:59], v[24:27], v[184:187]
    v_add_u32 v6, s51, v6
    v_mfma_f32_16x16x32_bf16 v[188:191], v[32:35], v[28:31], v[188:191]
    v_mfma_f32_16x16x32_bf16 v[192:195], v[36:39], v[28:31], v[192:195]
    v_mfma_f32_16x16x32_bf16 v[196:199], v[40:43], v[28:31], v[196:199]
    v_mfma_f32_16x16x32_bf16 v[200:203], v[44:47], v[28:31], v[200:203]
    v_mfma_f32_16x16x32_bf16 v[204:207], v[48:51], v[28:31], v[204:207]
    v_mfma_f32_16x16x32_bf16 v[208:211], v[52:55], v[28:31], v[208:211]
    v_mfma_f32_16x16x32_bf16 v[212:215], v[56:59], v[28:31], v[212:215]
    s_waitcnt lgkmcnt(0)
    v_mfma_f32_16x16x32_bf16 v[104:107], v[76:79], v[60:63], v[104:107]
    s_barrier
    v_add_u32 v8, s51, v8
    v_add_u32 v9, s51, v9
    v_add_u32 v10, s51, v10
    v_mfma_f32_16x16x32_bf16 v[108:111], v[80:83], v[60:63], v[108:111]
    ds_read_b128 v[16:19], v6 offset:0
    v_mfma_f32_16x16x32_bf16 v[112:115], v[84:87], v[60:63], v[112:115]
    ds_read_b64_tr_b16 v[32:33], v8 offset:0
    v_mfma_f32_16x16x32_bf16 v[116:119], v[88:91], v[60:63], v[116:119]
    ds_read_b64_tr_b16 v[34:35], v8 offset:1792
    v_mfma_f32_16x16x32_bf16 v[120:123], v[92:95], v[60:63], v[120:123]
    ds_read_b64_tr_b16 v[36:37], v9 offset:32
    v_mfma_f32_16x16x32_bf16 v[124:127], v[96:99], v[60:63], v[124:127]
    ds_read_b64_tr_b16 v[38:39], v9 offset:1824
    v_mfma_f32_16x16x32_bf16 v[128:131], v[100:103], v[60:63], v[128:131]
    ds_read_b64_tr_b16 v[40:41], v8 offset:64
    v_mfma_f32_16x16x32_bf16 v[132:135], v[76:79], v[64:67], v[132:135]
    ds_read_b64_tr_b16 v[42:43], v8 offset:1856
    v_mfma_f32_16x16x32_bf16 v[136:139], v[80:83], v[64:67], v[136:139]
    ds_read_b64_tr_b16 v[44:45], v9 offset:96
    v_mfma_f32_16x16x32_bf16 v[140:143], v[84:87], v[64:67], v[140:143]
    ds_read_b64_tr_b16 v[46:47], v9 offset:1888
    v_mfma_f32_16x16x32_bf16 v[144:147], v[88:91], v[64:67], v[144:147]
    ds_read_b64_tr_b16 v[48:49], v8 offset:128
    v_mfma_f32_16x16x32_bf16 v[148:151], v[92:95], v[64:67], v[148:151]
    ds_read_b64_tr_b16 v[50:51], v8 offset:1920
    v_mfma_f32_16x16x32_bf16 v[152:155], v[96:99], v[64:67], v[152:155]
    ds_read_b64_tr_b16 v[52:53], v9 offset:160
    v_mfma_f32_16x16x32_bf16 v[156:159], v[100:103], v[64:67], v[156:159]
    ds_read_b64_tr_b16 v[54:55], v9 offset:1952
    v_mfma_f32_16x16x32_bf16 v[160:163], v[76:79], v[68:71], v[160:163]
    ds_read_b64_tr_b16 v[56:57], v10 offset:0
    v_mfma_f32_16x16x32_bf16 v[164:167], v[80:83], v[68:71], v[164:167]
    ds_read_b64_tr_b16 v[58:59], v10 offset:1792
    v_mfma_f32_16x16x32_bf16 v[168:171], v[84:87], v[68:71], v[168:171]
    ds_read_b128 v[20:23], v6 offset:256
    v_mfma_f32_16x16x32_bf16 v[172:175], v[88:91], v[68:71], v[172:175]
    ds_read_b128 v[24:27], v6 offset:512
    v_mfma_f32_16x16x32_bf16 v[176:179], v[92:95], v[68:71], v[176:179]
    ds_read_b128 v[28:31], v6 offset:768
    v_mfma_f32_16x16x32_bf16 v[180:183], v[96:99], v[68:71], v[180:183]
    v_add_u32 v7, s51, v7
    v_mfma_f32_16x16x32_bf16 v[184:187], v[100:103], v[68:71], v[184:187]
    s_add_u32 s52, s52, 1
    v_mfma_f32_16x16x32_bf16 v[188:191], v[76:79], v[72:75], v[188:191]
    s_cmp_lt_u32 s52, 16
    v_mfma_f32_16x16x32_bf16 v[192:195], v[80:83], v[72:75], v[192:195]
    v_mfma_f32_16x16x32_bf16 v[196:199], v[84:87], v[72:75], v[196:199]
    v_mfma_f32_16x16x32_bf16 v[200:203], v[88:91], v[72:75], v[200:203]
    v_mfma_f32_16x16x32_bf16 v[204:207], v[92:95], v[72:75], v[204:207]
    v_mfma_f32_16x16x32_bf16 v[208:211], v[96:99], v[72:75], v[208:211]
    v_mfma_f32_16x16x32_bf16 v[212:215], v[100:103], v[72:75], v[212:215]
    s_cbranch_scc1 m_kernel_c3
m_kernel_padb6:
    s_cbranch_execz m_kernel_padb7
    s_waitcnt lgkmcnt(0)
    v_mov_b32 v14, 0xc0135761
    v_mov_b32 v15, v14
    v_and_b32 v2, 15, v1
    v_add_u32 v2, s46, v2
    v_lshlrev_b32 v2, 3, v2
    v_add_u32 v2, 155648, v2
    v_lshrrev_b32 v3, 4, v1
    v_lshlrev_b32 v3, 4, v3
    s_lshl_b32 s40, s33, 9
    s_add_u32 s40, s40, 156672
    v_add_u32 v4, s40, v3
    s_lshl_b32 s40, s33, 6
    s_add_u32 s40, s40, 157056
    v_add_u32 v5, s40, v3
    ds_read_b64 v[16:17], v2 offset:0
    ds_read_b64 v[18:19], v2 offset:128
    ds_read_b64 v[20:21], v2 offset:256
    ds_read_b64 v[22:23], v2 offset:384
    ds_read_b128 v[24:27], v4 offset:0
    ds_read_b128 v[28:31], v4 offset:64
    ds_read_b128 v[32:35], v4 offset:128
    ds_read_b128 v[36:39], v4 offset:192
    ds_read_b128 v[40:43], v4 offset:256
    ds_read_b128 v[44:47], v4 offset:320
    ds_read_b128 v[48:51], v5
    s_lshl_b32 s49, s33, 15
    v_and_b32 v2, 15, v1
    v_add_u32 v2, s46, v2
    v_bfe_u32 v3, v1, 4, 1
    v_lshrrev_b32 v4, 5, v1
    v_lshl_add_u32 v3, v3, 1, v4
    v_lshlrev_b32 v3, 11, v3
    v_lshl_add_u32 v2, v2, 4, v3
    v_add_u32 v8, s49, v2
    v_add_u32 v9, 8192, v8
    v_add_u32 v10, 16384, v8
    v_and_b32 v2, 31, v1
    v_add_u32 v2, s46, v2
    v_lshrrev_b32 v3, 5, v1
    v_lshlrev_b32 v3, 11, v3
    v_lshl_add_u32 v2, v2, 4, v3
    s_lshl_b32 s40, s33, 12
    s_add_u32 s40, s40, 24576
    v_add_u32 v12, s40, v2
    s_lshl4_add_u32 s44, s36, s37
    s_mul_i32 s44, s44, 57344
    s_add_u32 s44, s44, 0x1680000
    s_waitcnt lgkmcnt(0)
    v_pk_mul_f32 v[56:57], v[24:25], v[16:17] op_sel_hi:[1,0]
m_kernel_padb7:
    s_cbranch_execz m_kernel_wret2
    v_pk_fma_f32 v[104:105], v[104:105], v[16:17], v[56:57] op_sel:[0,1,0] op_sel_hi:[1,1,1]
    v_pk_mul_f32 v[58:59], v[26:27], v[16:17] op_sel_hi:[1,0]
    v_pk_fma_f32 v[106:107], v[106:107], v[16:17], v[58:59] op_sel:[0,1,0] op_sel_hi:[1,1,1]
    v_pk_mul_f32 v[60:61], v[28:29], v[16:17] op_sel_hi:[1,0]
    v_pk_fma_f32 v[108:109], v[108:109], v[16:17], v[60:61] op_sel:[0,1,0] op_sel_hi:[1,1,1]
    v_pk_mul_f32 v[62:63], v[30:31], v[16:17] op_sel_hi:[1,0]
    v_pk_fma_f32 v[110:111], v[110:111], v[16:17], v[62:63] op_sel:[0,1,0] op_sel_hi:[1,1,1]
    v_pk_mul_f32 v[56:57], v[104:105], v[104:105]
    v_pk_mul_f32 v[58:59], v[106:107], v[106:107]
    v_pk_mul_f32 v[60:61], v[108:109], v[108:109]
    v_pk_mul_f32 v[62:63], v[110:111], v[110:111]
    v_pk_fma_f32 v[56:57], v[56:57], s[70:71], v[14:15]
    v_pk_fma_f32 v[58:59], v[58:59], s[70:71], v[14:15]
    v_pk_fma_f32 v[60:61], v[60:61], s[70:71], v[14:15]
    v_pk_fma_f32 v[62:63], v[62:63], s[70:71], v[14:15]
    v_pk_mul_f32 v[56:57], v[56:57], v[104:105]
    v_pk_mul_f32 v[58:59], v[58:59], v[106:107]
    v_pk_mul_f32 v[60:61], v[60:61], v[108:109]
    v_pk_mul_f32 v[62:63], v[62:63], v[110:111]
    v_exp_f32 v56, v56
    v_exp_f32 v57, v57
    v_exp_f32 v58, v58
    v_exp_f32 v59, v59
    v_exp_f32 v60, v60
    v_exp_f32 v61, v61
    v_exp_f32 v62, v62
    v_exp_f32 v63, v63
    v_pk_add_f32 v[56:57], v[56:57], 1.0 op_sel_hi:[1,0]
    v_pk_add_f32 v[58:59], v[58:59], 1.0 op_sel_hi:[1,0]
    v_pk_add_f32 v[60:61], v[60:61], 1.0 op_sel_hi:[1,0]
    v_pk_add_f32 v[62:63], v[62:63], 1.0 op_sel_hi:[1,0]
    v_rcp_f32 v56, v56
    v_rcp_f32 v57, v57
    v_rcp_f32 v58, v58
    v_rcp_f32 v59, v59
    v_rcp_f32 v60, v60
    v_rcp_f32 v61, v61
    v_rcp_f32 v62, v62
    v_rcp_f32 v63, v63
    v_pk_mul_f32 v[104:105], v[104:105], v[56:57]
    v_pk_mul_f32 v[106:107], v[106:107], v[58:59]
    v_pk_mul_f32 v[108:109], v[108:109], v[60:61]
    v_pk_mul_f32 v[110:111], v[110:111], v[62:63]
    v_cvt_pk_bf16_f32 v72, v104, v105
    v_cvt_pk_bf16_f32 v73, v106, v107
    v_cvt_pk_bf16_f32 v74, v108, v109
m_kernel_padb8:
    s_cbranch_execz m_kernel_padb9
    v_cvt_pk_bf16_f32 v75, v110, v111
    s_nop 1
    v_permlane16_swap_b32 v72, v74
    v_permlane16_swap_b32 v73, v75
    buffer_store_dwordx4 v[72:75], v8, s[16:19], s44 offen offset:0 sc1
    v_pk_mul_f32 v[64:65], v[32:33], v[16:17] op_sel_hi:[1,0]
    v_pk_fma_f32 v[112:113], v[112:113], v[16:17], v[64:65] op_sel:[0,1,0] op_sel_hi:[1,1,1]
    v_pk_mul_f32 v[66:67], v[34:35], v[16:17] op_sel_hi:[1,0]
    v_pk_fma_f32 v[114:115], v[114:115], v[16:17], v[66:67] op_sel:[0,1,0] op_sel_hi:[1,1,1]
    v_pk_mul_f32 v[68:69], v[36:37], v[16:17] op_sel_hi:[1,0]
    v_pk_fma_f32 v[116:117], v[116:117], v[16:17], v[68:69] op_sel:[0,1,0] op_sel_hi:[1,1,1]
    v_pk_mul_f32 v[70:71], v[38:39], v[16:17] op_sel_hi:[1,0]
    v_pk_fma_f32 v[118:119], v[118:119], v[16:17], v[70:71] op_sel:[0,1,0] op_sel_hi:[1,1,1]
    v_pk_mul_f32 v[64:65], v[112:113], v[112:113]
    v_pk_mul_f32 v[66:67], v[114:115], v[114:115]
    v_pk_mul_f32 v[68:69], v[116:117], v[116:117]
    v_pk_mul_f32 v[70:71], v[118:119], v[118:119]
    v_pk_fma_f32 v[64:65], v[64:65], s[70:71], v[14:15]
    v_pk_fma_f32 v[66:67], v[66:67], s[70:71], v[14:15]
    v_pk_fma_f32 v[68:69], v[68:69], s[70:71], v[14:15]
    v_pk_fma_f32 v[70:71], v[70:71], s[70:71], v[14:15]
    v_pk_mul_f32 v[64:65], v[64:65], v[112:113]
    v_pk_mul_f32 v[66:67], v[66:67], v[114:115]
    v_pk_mul_f32 v[68:69], v[68:69], v[116:117]
    v_pk_mul_f32 v[70:71], v[70:71], v[118:119]
    v_exp_f32 v64, v64
    v_exp_f32 v65, v65
    v_exp_f32 v66, v66
    v_exp_f32 v67, v67
    v_exp_f32 v68, v68
    v_exp_f32 v69, v69
    v_exp_f32 v70, v70
    v_exp_f32 v71, v71
    v_pk_add_f32 v[64:65], v[64:65], 1.0 op_sel_hi:[1,0]
    v_pk_add_f32 v[66:67], v[66:67], 1.0 op_sel_hi:[1,0]
    v_pk_add_f32 v[68:69], v[68:69], 1.0 op_sel_hi:[1,0]
    v_pk_add_f32 v[70:71], v[70:71], 1.0 op_sel_hi:[1,0]
    v_rcp_f32 v64, v64
    v_rcp_f32 v65, v65
    v_rcp_f32 v66, v66
    v_rcp_f32 v67, v67
    v_rcp_f32 v68, v68
    v_rcp_f32 v69, v69
    v_rcp_f32 v70, v70
    v_rcp_f32 v71, v71
    v_pk_mul_f32 v[112:113], v[112:113], v[64:65]
    v_pk_mul_f32 v[114:115], v[114:115], v[66:67]
m_kernel_padb9:
    s_cbranch_execz m_kernel_wret2
    v_pk_mul_f32 v[116:117], v[116:117], v[68:69]
    v_pk_mul_f32 v[118:119], v[118:119], v[70:71]
    v_cvt_pk_bf16_f32 v76, v112, v113
    v_cvt_pk_bf16_f32 v77, v114, v115
    v_cvt_pk_bf16_f32 v78, v116, v117
    v_cvt_pk_bf16_f32 v79, v118, v119
    s_nop 1
    v_permlane16_swap_b32 v76, v78
    v_permlane16_swap_b32 v77, v79
    buffer_store_dwordx4 v[76:79], v9, s[16:19], s44 offen offset:0 sc1
    v_pk_mul_f32 v[56:57], v[40:41], v[16:17] op_sel_hi:[1,0]
    v_pk_fma_f32 v[120:121], v[120:121], v[16:17], v[56:57] op_sel:[0,1,0] op_sel_hi:[1,1,1]
    v_pk_mul_f32 v[58:59], v[42:43], v[16:17] op_sel_hi:[1,0]
    v_pk_fma_f32 v[122:123], v[122:123], v[16:17], v[58:59] op_sel:[0,1,0] op_sel_hi:[1,1,1]
    v_pk_mul_f32 v[60:61], v[44:45], v[16:17] op_sel_hi:[1,0]
    v_pk_fma_f32 v[124:125], v[124:125], v[16:17], v[60:61] op_sel:[0,1,0] op_sel_hi:[1,1,1]
    v_pk_mul_f32 v[62:63], v[46:47], v[16:17] op_sel_hi:[1,0]
    v_pk_fma_f32 v[126:127], v[126:127], v[16:17], v[62:63] op_sel:[0,1,0] op_sel_hi:[1,1,1]
    v_pk_mul_f32 v[56:57], v[120:121], v[120:121]
    v_pk_mul_f32 v[58:59], v[122:123], v[122:123]
    v_pk_mul_f32 v[60:61], v[124:125], v[124:125]
    v_pk_mul_f32 v[62:63], v[126:127], v[126:127]
    v_pk_fma_f32 v[56:57], v[56:57], s[70:71], v[14:15]
    v_pk_fma_f32 v[58:59], v[58:59], s[70:71], v[14:15]
    v_pk_fma_f32 v[60:61], v[60:61], s[70:71], v[14:15]
    v_pk_fma_f32 v[62:63], v[62:63], s[70:71], v[14:15]
    v_pk_mul_f32 v[56:57], v[56:57], v[120:121]
    v_pk_mul_f32 v[58:59], v[58:59], v[122:123]
    v_pk_mul_f32 v[60:61], v[60:61], v[124:125]
    v_pk_mul_f32 v[62:63], v[62:63], v[126:127]
    v_exp_f32 v56, v56
    v_exp_f32 v57, v57
    v_exp_f32 v58, v58
    v_exp_f32 v59, v59
    v_exp_f32 v60, v60
    v_exp_f32 v61, v61
    v_exp_f32 v62, v62
    v_exp_f32 v63, v63
    v_pk_add_f32 v[56:57], v[56:57], 1.0 op_sel_hi:[1,0]
    v_pk_add_f32 v[58:59], v[58:59], 1.0 op_sel_hi:[1,0]
    v_pk_add_f32 v[60:61], v[60:61], 1.0 op_sel_hi:[1,0]
    v_pk_add_f32 v[62:63], v[62:63], 1.0 op_sel_hi:[1,0]
    v_rcp_f32 v56, v56
    v_rcp_f32 v57, v57
m_kernel_padb10:
    s_cbranch_execz m_kernel_padb11
    v_rcp_f32 v58, v58
    v_rcp_f32 v59, v59
    v_rcp_f32 v60, v60
    v_rcp_f32 v61, v61
    v_rcp_f32 v62, v62
    v_rcp_f32 v63, v63
    v_pk_mul_f32 v[120:121], v[120:121], v[56:57]
    v_pk_mul_f32 v[122:123], v[122:123], v[58:59]
    v_pk_mul_f32 v[124:125], v[124:125], v[60:61]
    v_pk_mul_f32 v[126:127], v[126:127], v[62:63]
    v_cvt_pk_bf16_f32 v80, v120, v121
    v_cvt_pk_bf16_f32 v81, v122, v123
    v_cvt_pk_bf16_f32 v82, v124, v125
    v_cvt_pk_bf16_f32 v83, v126, v127
    s_nop 1
    v_permlane16_swap_b32 v80, v82
    v_permlane16_swap_b32 v81, v83
    buffer_store_dwordx4 v[80:83], v10, s[16:19], s44 offen offset:0 sc1
    v_pk_mul_f32 v[64:65], v[24:25], v[18:19] op_sel_hi:[1,0]
    v_pk_fma_f32 v[132:133], v[132:133], v[18:19], v[64:65] op_sel:[0,1,0] op_sel_hi:[1,1,1]
    v_pk_mul_f32 v[66:67], v[26:27], v[18:19] op_sel_hi:[1,0]
    v_pk_fma_f32 v[134:135], v[134:135], v[18:19], v[66:67] op_sel:[0,1,0] op_sel_hi:[1,1,1]
    v_pk_mul_f32 v[68:69], v[28:29], v[18:19] op_sel_hi:[1,0]
    v_pk_fma_f32 v[136:137], v[136:137], v[18:19], v[68:69] op_sel:[0,1,0] op_sel_hi:[1,1,1]
    v_pk_mul_f32 v[70:71], v[30:31], v[18:19] op_sel_hi:[1,0]
    v_pk_fma_f32 v[138:139], v[138:139], v[18:19], v[70:71] op_sel:[0,1,0] op_sel_hi:[1,1,1]
    v_pk_mul_f32 v[64:65], v[132:133], v[132:133]
    v_pk_mul_f32 v[66:67], v[134:135], v[134:135]
    v_pk_mul_f32 v[68:69], v[136:137], v[136:137]
    v_pk_mul_f32 v[70:71], v[138:139], v[138:139]
    v_pk_fma_f32 v[64:65], v[64:65], s[70:71], v[14:15]
    v_pk_fma_f32 v[66:67], v[66:67], s[70:71], v[14:15]
    v_pk_fma_f32 v[68:69], v[68:69], s[70:71], v[14:15]
    v_pk_fma_f32 v[70:71], v[70:71], s[70:71], v[14:15]
    v_pk_mul_f32 v[64:65], v[64:65], v[132:133]
    v_pk_mul_f32 v[66:67], v[66:67], v[134:135]
    v_pk_mul_f32 v[68:69], v[68:69], v[136:137]
    v_pk_mul_f32 v[70:71], v[70:71], v[138:139]
    v_exp_f32 v64, v64
    v_exp_f32 v65, v65
    v_exp_f32 v66, v66
    v_exp_f32 v67, v67
    v_exp_f32 v68, v68
    v_exp_f32 v69, v69
    v_exp_f32 v70, v70
    v_exp_f32 v71, v71
m_kernel_padb11:
    s_cbranch_execz m_kernel_wret2
    v_pk_add_f32 v[64:65], v[64:65], 1.0 op_sel_hi:[1,0]
    v_pk_add_f32 v[66:67], v[66:67], 1.0 op_sel_hi:[1,0]
    v_pk_add_f32 v[68:69], v[68:69], 1.0 op_sel_hi:[1,0]
    v_pk_add_f32 v[70:71], v[70:71], 1.0 op_sel_hi:[1,0]
    v_rcp_f32 v64, v64
    v_rcp_f32 v65, v65
    v_rcp_f32 v66, v66
    v_rcp_f32 v67, v67
    v_rcp_f32 v68, v68
    v_rcp_f32 v69, v69
    v_rcp_f32 v70, v70
    v_rcp_f32 v71, v71
    v_pk_mul_f32 v[132:133], v[132:133], v[64:65]
    v_pk_mul_f32 v[134:135], v[134:135], v[66:67]
    v_pk_mul_f32 v[136:137], v[136:137], v[68:69]
    v_pk_mul_f32 v[138:139], v[138:139], v[70:71]
    v_cvt_pk_bf16_f32 v84, v132, v133
    v_cvt_pk_bf16_f32 v85, v134, v135
    v_cvt_pk_bf16_f32 v86, v136, v137
    v_cvt_pk_bf16_f32 v87, v138, v139
    s_nop 1
    v_permlane16_swap_b32 v84, v86
    v_permlane16_swap_b32 v85, v87
    buffer_store_dwordx4 v[84:87], v8, s[16:19], s44 offen offset:256 sc1
    v_pk_mul_f32 v[56:57], v[32:33], v[18:19] op_sel_hi:[1,0]
    v_pk_fma_f32 v[140:141], v[140:141], v[18:19], v[56:57] op_sel:[0,1,0] op_sel_hi:[1,1,1]
    v_pk_mul_f32 v[58:59], v[34:35], v[18:19] op_sel_hi:[1,0]
    v_pk_fma_f32 v[142:143], v[142:143], v[18:19], v[58:59] op_sel:[0,1,0] op_sel_hi:[1,1,1]
    v_pk_mul_f32 v[60:61], v[36:37], v[18:19] op_sel_hi:[1,0]
    v_pk_fma_f32 v[144:145], v[144:145], v[18:19], v[60:61] op_sel:[0,1,0] op_sel_hi:[1,1,1]
    v_pk_mul_f32 v[62:63], v[38:39], v[18:19] op_sel_hi:[1,0]
    v_pk_fma_f32 v[146:147], v[146:147], v[18:19], v[62:63] op_sel:[0,1,0] op_sel_hi:[1,1,1]
    v_pk_mul_f32 v[56:57], v[140:141], v[140:141]
    v_pk_mul_f32 v[58:59], v[142:143], v[142:143]
    v_pk_mul_f32 v[60:61], v[144:145], v[144:145]
    v_pk_mul_f32 v[62:63], v[146:147], v[146:147]
    v_pk_fma_f32 v[56:57], v[56:57], s[70:71], v[14:15]
    v_pk_fma_f32 v[58:59], v[58:59], s[70:71], v[14:15]
    v_pk_fma_f32 v[60:61], v[60:61], s[70:71], v[14:15]
    v_pk_fma_f32 v[62:63], v[62:63], s[70:71], v[14:15]
    v_pk_mul_f32 v[56:57], v[56:57], v[140:141]
    v_pk_mul_f32 v[58:59], v[58:59], v[142:143]
    v_pk_mul_f32 v[60:61], v[60:61], v[144:145]
m_kernel_padb12:
    s_cbranch_execz m_kernel_padb13
    v_pk_mul_f32 v[62:63], v[62:63], v[146:147]
    v_exp_f32 v56, v56
    v_exp_f32 v57, v57
    v_exp_f32 v58, v58
    v_exp_f32 v59, v59
    v_exp_f32 v60, v60
    v_exp_f32 v61, v61
    v_exp_f32 v62, v62
    v_exp_f32 v63, v63
    v_pk_add_f32 v[56:57], v[56:57], 1.0 op_sel_hi:[1,0]
    v_pk_add_f32 v[58:59], v[58:59], 1.0 op_sel_hi:[1,0]
    v_pk_add_f32 v[60:61], v[60:61], 1.0 op_sel_hi:[1,0]
    v_pk_add_f32 v[62:63], v[62:63], 1.0 op_sel_hi:[1,0]
    v_rcp_f32 v56, v56
    v_rcp_f32 v57, v57
    v_rcp_f32 v58, v58
    v_rcp_f32 v59, v59
    v_rcp_f32 v60, v60
    v_rcp_f32 v61, v61
    v_rcp_f32 v62, v62
    v_rcp_f32 v63, v63
    v_pk_mul_f32 v[140:141], v[140:141], v[56:57]
    v_pk_mul_f32 v[142:143], v[142:143], v[58:59]
    v_pk_mul_f32 v[144:145], v[144:145], v[60:61]
    v_pk_mul_f32 v[146:147], v[146:147], v[62:63]
    v_cvt_pk_bf16_f32 v72, v140, v141
    v_cvt_pk_bf16_f32 v73, v142, v143
    v_cvt_pk_bf16_f32 v74, v144, v145
    v_cvt_pk_bf16_f32 v75, v146, v147
    s_nop 1
    v_permlane16_swap_b32 v72, v74
    v_permlane16_swap_b32 v73, v75
    buffer_store_dwordx4 v[72:75], v9, s[16:19], s44 offen offset:256 sc1
    v_pk_mul_f32 v[64:65], v[40:41], v[18:19] op_sel_hi:[1,0]
    v_pk_fma_f32 v[148:149], v[148:149], v[18:19], v[64:65] op_sel:[0,1,0] op_sel_hi:[1,1,1]
    v_pk_mul_f32 v[66:67], v[42:43], v[18:19] op_sel_hi:[1,0]
    v_pk_fma_f32 v[150:151], v[150:151], v[18:19], v[66:67] op_sel:[0,1,0] op_sel_hi:[1,1,1]
    v_pk_mul_f32 v[68:69], v[44:45], v[18:19] op_sel_hi:[1,0]
    v_pk_fma_f32 v[152:153], v[152:153], v[18:19], v[68:69] op_sel:[0,1,0] op_sel_hi:[1,1,1]
    v_pk_mul_f32 v[70:71], v[46:47], v[18:19] op_sel_hi:[1,0]
    v_pk_fma_f32 v[154:155], v[154:155], v[18:19], v[70:71] op_sel:[0,1,0] op_sel_hi:[1,1,1]
    v_pk_mul_f32 v[64:65], v[148:149], v[148:149]
    v_pk_mul_f32 v[66:67], v[150:151], v[150:151]
    v_pk_mul_f32 v[68:69], v[152:153], v[152:153]
    v_pk_mul_f32 v[70:71], v[154:155], v[154:155]
    v_pk_fma_f32 v[64:65], v[64:65], s[70:71], v[14:15]
    v_pk_fma_f32 v[66:67], v[66:67], s[70:71], v[14:15]
m_kernel_padb13:
    s_cbranch_execz m_kernel_wret2
    v_pk_fma_f32 v[68:69], v[68:69], s[70:71], v[14:15]
    v_pk_fma_f32 v[70:71], v[70:71], s[70:71], v[14:15]
    v_pk_mul_f32 v[64:65], v[64:65], v[148:149]
    v_pk_mul_f32 v[66:67], v[66:67], v[150:151]
    v_pk_mul_f32 v[68:69], v[68:69], v[152:153]
    v_pk_mul_f32 v[70:71], v[70:71], v[154:155]
    v_exp_f32 v64, v64
    v_exp_f32 v65, v65
    v_exp_f32 v66, v66
    v_exp_f32 v67, v67
    v_exp_f32 v68, v68
    v_exp_f32 v69, v69
    v_exp_f32 v70, v70
    v_exp_f32 v71, v71
    v_pk_add_f32 v[64:65], v[64:65], 1.0 op_sel_hi:[1,0]
    v_pk_add_f32 v[66:67], v[66:67], 1.0 op_sel_hi:[1,0]
    v_pk_add_f32 v[68:69], v[68:69], 1.0 op_sel_hi:[1,0]
    v_pk_add_f32 v[70:71], v[70:71], 1.0 op_sel_hi:[1,0]
    v_rcp_f32 v64, v64
    v_rcp_f32 v65, v65
    v_rcp_f32 v66, v66
    v_rcp_f32 v67, v67
    v_rcp_f32 v68, v68
    v_rcp_f32 v69, v69
    v_rcp_f32 v70, v70
    v_rcp_f32 v71, v71
    v_pk_mul_f32 v[148:149], v[148:149], v[64:65]
    v_pk_mul_f32 v[150:151], v[150:151], v[66:67]
    v_pk_mul_f32 v[152:153], v[152:153], v[68:69]
    v_pk_mul_f32 v[154:155], v[154:155], v[70:71]
    v_cvt_pk_bf16_f32 v76, v148, v149
    v_cvt_pk_bf16_f32 v77, v150, v151
    v_cvt_pk_bf16_f32 v78, v152, v153
    v_cvt_pk_bf16_f32 v79, v154, v155
    s_nop 1
    v_permlane16_swap_b32 v76, v78
    v_permlane16_swap_b32 v77, v79
    buffer_store_dwordx4 v[76:79], v10, s[16:19], s44 offen offset:256 sc1
    v_pk_mul_f32 v[56:57], v[48:49], v[16:17] op_sel_hi:[1,0]
    v_pk_fma_f32 v[128:129], v[128:129], v[16:17], v[56:57] op_sel:[0,1,0] op_sel_hi:[1,1,1]
    v_pk_mul_f32 v[58:59], v[50:51], v[16:17] op_sel_hi:[1,0]
    v_pk_fma_f32 v[130:131], v[130:131], v[16:17], v[58:59] op_sel:[0,1,0] op_sel_hi:[1,1,1]
    v_pk_mul_f32 v[60:61], v[48:49], v[18:19] op_sel_hi:[1,0]
    v_pk_fma_f32 v[156:157], v[156:157], v[18:19], v[60:61] op_sel:[0,1,0] op_sel_hi:[1,1,1]
    v_pk_mul_f32 v[62:63], v[50:51], v[18:19] op_sel_hi:[1,0]
    v_pk_fma_f32 v[158:159], v[158:159], v[18:19], v[62:63] op_sel:[0,1,0] op_sel_hi:[1,1,1]
    v_pk_mul_f32 v[56:57], v[128:129], v[128:129]
m_kernel_padb14:
    s_cbranch_execz m_kernel_padb15
    v_pk_mul_f32 v[58:59], v[130:131], v[130:131]
    v_pk_mul_f32 v[60:61], v[156:157], v[156:157]
    v_pk_mul_f32 v[62:63], v[158:159], v[158:159]
    v_pk_fma_f32 v[56:57], v[56:57], s[70:71], v[14:15]
    v_pk_fma_f32 v[58:59], v[58:59], s[70:71], v[14:15]
    v_pk_fma_f32 v[60:61], v[60:61], s[70:71], v[14:15]
    v_pk_fma_f32 v[62:63], v[62:63], s[70:71], v[14:15]
    v_pk_mul_f32 v[56:57], v[56:57], v[128:129]
    v_pk_mul_f32 v[58:59], v[58:59], v[130:131]
    v_pk_mul_f32 v[60:61], v[60:61], v[156:157]
    v_pk_mul_f32 v[62:63], v[62:63], v[158:159]
    v_exp_f32 v56, v56
    v_exp_f32 v57, v57
    v_exp_f32 v58, v58
    v_exp_f32 v59, v59
    v_exp_f32 v60, v60
    v_exp_f32 v61, v61
    v_exp_f32 v62, v62
    v_exp_f32 v63, v63
    v_pk_add_f32 v[56:57], v[56:57], 1.0 op_sel_hi:[1,0]
    v_pk_add_f32 v[58:59], v[58:59], 1.0 op_sel_hi:[1,0]
    v_pk_add_f32 v[60:61], v[60:61], 1.0 op_sel_hi:[1,0]
    v_pk_add_f32 v[62:63], v[62:63], 1.0 op_sel_hi:[1,0]
    v_rcp_f32 v56, v56
    v_rcp_f32 v57, v57
    v_rcp_f32 v58, v58
    v_rcp_f32 v59, v59
    v_rcp_f32 v60, v60
    v_rcp_f32 v61, v61
    v_rcp_f32 v62, v62
    v_rcp_f32 v63, v63
    v_pk_mul_f32 v[128:129], v[128:129], v[56:57]
    v_pk_mul_f32 v[130:131], v[130:131], v[58:59]
    v_pk_mul_f32 v[156:157], v[156:157], v[60:61]
    v_pk_mul_f32 v[158:159], v[158:159], v[62:63]
    v_cvt_pk_bf16_f32 v80, v128, v129
    v_cvt_pk_bf16_f32 v81, v130, v131
    v_cvt_pk_bf16_f32 v82, v156, v157
    v_cvt_pk_bf16_f32 v83, v158, v159
    s_nop 1
    v_permlane16_swap_b32 v80, v82
    v_permlane16_swap_b32 v81, v83
    buffer_store_dwordx4 v[80:83], v12, s[16:19], s44 offen offset:0 sc1
    v_pk_mul_f32 v[64:65], v[24:25], v[20:21] op_sel_hi:[1,0]
    v_pk_fma_f32 v[160:161], v[160:161], v[20:21], v[64:65] op_sel:[0,1,0] op_sel_hi:[1,1,1]
    v_pk_mul_f32 v[66:67], v[26:27], v[20:21] op_sel_hi:[1,0]
    v_pk_fma_f32 v[162:163], v[162:163], v[20:21], v[66:67] op_sel:[0,1,0] op_sel_hi:[1,1,1]
m_kernel_padb15:
    s_cbranch_execz m_kernel_wret2
    v_pk_mul_f32 v[68:69], v[28:29], v[20:21] op_sel_hi:[1,0]
    v_pk_fma_f32 v[164:165], v[164:165], v[20:21], v[68:69] op_sel:[0,1,0] op_sel_hi:[1,1,1]
    v_pk_mul_f32 v[70:71], v[30:31], v[20:21] op_sel_hi:[1,0]
    v_pk_fma_f32 v[166:167], v[166:167], v[20:21], v[70:71] op_sel:[0,1,0] op_sel_hi:[1,1,1]
    v_pk_mul_f32 v[64:65], v[160:161], v[160:161]
    v_pk_mul_f32 v[66:67], v[162:163], v[162:163]
    v_pk_mul_f32 v[68:69], v[164:165], v[164:165]
    v_pk_mul_f32 v[70:71], v[166:167], v[166:167]
    v_pk_fma_f32 v[64:65], v[64:65], s[70:71], v[14:15]
    v_pk_fma_f32 v[66:67], v[66:67], s[70:71], v[14:15]
    v_pk_fma_f32 v[68:69], v[68:69], s[70:71], v[14:15]
    v_pk_fma_f32 v[70:71], v[70:71], s[70:71], v[14:15]
    v_pk_mul_f32 v[64:65], v[64:65], v[160:161]
    v_pk_mul_f32 v[66:67], v[66:67], v[162:163]
    v_pk_mul_f32 v[68:69], v[68:69], v[164:165]
    v_pk_mul_f32 v[70:71], v[70:71], v[166:167]
    v_exp_f32 v64, v64
    v_exp_f32 v65, v65
    v_exp_f32 v66, v66
    v_exp_f32 v67, v67
    v_exp_f32 v68, v68
    v_exp_f32 v69, v69
    v_exp_f32 v70, v70
    v_exp_f32 v71, v71
    v_pk_add_f32 v[64:65], v[64:65], 1.0 op_sel_hi:[1,0]
    v_pk_add_f32 v[66:67], v[66:67], 1.0 op_sel_hi:[1,0]
    v_pk_add_f32 v[68:69], v[68:69], 1.0 op_sel_hi:[1,0]
    v_pk_add_f32 v[70:71], v[70:71], 1.0 op_sel_hi:[1,0]
    v_rcp_f32 v64, v64
    v_rcp_f32 v65, v65
    v_rcp_f32 v66, v66
    v_rcp_f32 v67, v67
    v_rcp_f32 v68, v68
    v_rcp_f32 v69, v69
    v_rcp_f32 v70, v70
    v_rcp_f32 v71, v71
    v_pk_mul_f32 v[160:161], v[160:161], v[64:65]
    v_pk_mul_f32 v[162:163], v[162:163], v[66:67]
    v_pk_mul_f32 v[164:165], v[164:165], v[68:69]
    v_pk_mul_f32 v[166:167], v[166:167], v[70:71]
    v_cvt_pk_bf16_f32 v84, v160, v161
    v_cvt_pk_bf16_f32 v85, v162, v163
    v_cvt_pk_bf16_f32 v86, v164, v165
    v_cvt_pk_bf16_f32 v87, v166, v167
    s_nop 1
    v_permlane16_swap_b32 v84, v86
    v_permlane16_swap_b32 v85, v87
m_kernel_padb16:
    s_cbranch_execz m_kernel_padb17
    buffer_store_dwordx4 v[84:87], v8, s[16:19], s44 offen offset:512 sc1
    v_pk_mul_f32 v[56:57], v[32:33], v[20:21] op_sel_hi:[1,0]
    v_pk_fma_f32 v[168:169], v[168:169], v[20:21], v[56:57] op_sel:[0,1,0] op_sel_hi:[1,1,1]
    v_pk_mul_f32 v[58:59], v[34:35], v[20:21] op_sel_hi:[1,0]
    v_pk_fma_f32 v[170:171], v[170:171], v[20:21], v[58:59] op_sel:[0,1,0] op_sel_hi:[1,1,1]
    v_pk_mul_f32 v[60:61], v[36:37], v[20:21] op_sel_hi:[1,0]
    v_pk_fma_f32 v[172:173], v[172:173], v[20:21], v[60:61] op_sel:[0,1,0] op_sel_hi:[1,1,1]
    v_pk_mul_f32 v[62:63], v[38:39], v[20:21] op_sel_hi:[1,0]
    v_pk_fma_f32 v[174:175], v[174:175], v[20:21], v[62:63] op_sel:[0,1,0] op_sel_hi:[1,1,1]
    v_pk_mul_f32 v[56:57], v[168:169], v[168:169]
    v_pk_mul_f32 v[58:59], v[170:171], v[170:171]
    v_pk_mul_f32 v[60:61], v[172:173], v[172:173]
    v_pk_mul_f32 v[62:63], v[174:175], v[174:175]
    v_pk_fma_f32 v[56:57], v[56:57], s[70:71], v[14:15]
    v_pk_fma_f32 v[58:59], v[58:59], s[70:71], v[14:15]
    v_pk_fma_f32 v[60:61], v[60:61], s[70:71], v[14:15]
    v_pk_fma_f32 v[62:63], v[62:63], s[70:71], v[14:15]
    v_pk_mul_f32 v[56:57], v[56:57], v[168:169]
    v_pk_mul_f32 v[58:59], v[58:59], v[170:171]
    v_pk_mul_f32 v[60:61], v[60:61], v[172:173]
    v_pk_mul_f32 v[62:63], v[62:63], v[174:175]
    v_exp_f32 v56, v56
    v_exp_f32 v57, v57
    v_exp_f32 v58, v58
    v_exp_f32 v59, v59
    v_exp_f32 v60, v60
    v_exp_f32 v61, v61
    v_exp_f32 v62, v62
    v_exp_f32 v63, v63
    v_pk_add_f32 v[56:57], v[56:57], 1.0 op_sel_hi:[1,0]
    v_pk_add_f32 v[58:59], v[58:59], 1.0 op_sel_hi:[1,0]
    v_pk_add_f32 v[60:61], v[60:61], 1.0 op_sel_hi:[1,0]
    v_pk_add_f32 v[62:63], v[62:63], 1.0 op_sel_hi:[1,0]
    v_rcp_f32 v56, v56
    v_rcp_f32 v57, v57
    v_rcp_f32 v58, v58
    v_rcp_f32 v59, v59
    v_rcp_f32 v60, v60
    v_rcp_f32 v61, v61
    v_rcp_f32 v62, v62
    v_rcp_f32 v63, v63
    v_pk_mul_f32 v[168:169], v[168:169], v[56:57]
    v_pk_mul_f32 v[170:171], v[170:171], v[58:59]
    v_pk_mul_f32 v[172:173], v[172:173], v[60:61]
    v_pk_mul_f32 v[174:175], v[174:175], v[62:63]
    v_cvt_pk_bf16_f32 v72, v168, v169
m_kernel_padb17:
    s_cbranch_execz m_kernel_wret2
    v_cvt_pk_bf16_f32 v73, v170, v171
    v_cvt_pk_bf16_f32 v74, v172, v173
    v_cvt_pk_bf16_f32 v75, v174, v175
    s_nop 1
    v_permlane16_swap_b32 v72, v74
    v_permlane16_swap_b32 v73, v75
    buffer_store_dwordx4 v[72:75], v9, s[16:19], s44 offen offset:512 sc1
    v_pk_mul_f32 v[64:65], v[40:41], v[20:21] op_sel_hi:[1,0]
    v_pk_fma_f32 v[176:177], v[176:177], v[20:21], v[64:65] op_sel:[0,1,0] op_sel_hi:[1,1,1]
    v_pk_mul_f32 v[66:67], v[42:43], v[20:21] op_sel_hi:[1,0]
    v_pk_fma_f32 v[178:179], v[178:179], v[20:21], v[66:67] op_sel:[0,1,0] op_sel_hi:[1,1,1]
    v_pk_mul_f32 v[68:69], v[44:45], v[20:21] op_sel_hi:[1,0]
    v_pk_fma_f32 v[180:181], v[180:181], v[20:21], v[68:69] op_sel:[0,1,0] op_sel_hi:[1,1,1]
    v_pk_mul_f32 v[70:71], v[46:47], v[20:21] op_sel_hi:[1,0]
    v_pk_fma_f32 v[182:183], v[182:183], v[20:21], v[70:71] op_sel:[0,1,0] op_sel_hi:[1,1,1]
    v_pk_mul_f32 v[64:65], v[176:177], v[176:177]
    v_pk_mul_f32 v[66:67], v[178:179], v[178:179]
    v_pk_mul_f32 v[68:69], v[180:181], v[180:181]
    v_pk_mul_f32 v[70:71], v[182:183], v[182:183]
    v_pk_fma_f32 v[64:65], v[64:65], s[70:71], v[14:15]
    v_pk_fma_f32 v[66:67], v[66:67], s[70:71], v[14:15]
    v_pk_fma_f32 v[68:69], v[68:69], s[70:71], v[14:15]
    v_pk_fma_f32 v[70:71], v[70:71], s[70:71], v[14:15]
    v_pk_mul_f32 v[64:65], v[64:65], v[176:177]
    v_pk_mul_f32 v[66:67], v[66:67], v[178:179]
    v_pk_mul_f32 v[68:69], v[68:69], v[180:181]
    v_pk_mul_f32 v[70:71], v[70:71], v[182:183]
    v_exp_f32 v64, v64
    v_exp_f32 v65, v65
    v_exp_f32 v66, v66
    v_exp_f32 v67, v67
    v_exp_f32 v68, v68
    v_exp_f32 v69, v69
    v_exp_f32 v70, v70
    v_exp_f32 v71, v71
    v_pk_add_f32 v[64:65], v[64:65], 1.0 op_sel_hi:[1,0]
    v_pk_add_f32 v[66:67], v[66:67], 1.0 op_sel_hi:[1,0]
    v_pk_add_f32 v[68:69], v[68:69], 1.0 op_sel_hi:[1,0]
    v_pk_add_f32 v[70:71], v[70:71], 1.0 op_sel_hi:[1,0]
    v_rcp_f32 v64, v64
    v_rcp_f32 v65, v65
    v_rcp_f32 v66, v66
    v_rcp_f32 v67, v67
    v_rcp_f32 v68, v68
    v_rcp_f32 v69, v69
    v_rcp_f32 v70, v70
    v_rcp_f32 v71, v71
m_kernel_padb18:
    s_cbranch_execz m_kernel_padb19
    v_pk_mul_f32 v[176:177], v[176:177], v[64:65]
    v_pk_mul_f32 v[178:179], v[178:179], v[66:67]
    v_pk_mul_f32 v[180:181], v[180:181], v[68:69]
    v_pk_mul_f32 v[182:183], v[182:183], v[70:71]
    v_cvt_pk_bf16_f32 v76, v176, v177
    v_cvt_pk_bf16_f32 v77, v178, v179
    v_cvt_pk_bf16_f32 v78, v180, v181
    v_cvt_pk_bf16_f32 v79, v182, v183
    s_nop 1
    v_permlane16_swap_b32 v76, v78
    v_permlane16_swap_b32 v77, v79
    buffer_store_dwordx4 v[76:79], v10, s[16:19], s44 offen offset:512 sc1
    v_pk_mul_f32 v[56:57], v[24:25], v[22:23] op_sel_hi:[1,0]
    v_pk_fma_f32 v[188:189], v[188:189], v[22:23], v[56:57] op_sel:[0,1,0] op_sel_hi:[1,1,1]
    v_pk_mul_f32 v[58:59], v[26:27], v[22:23] op_sel_hi:[1,0]
    v_pk_fma_f32 v[190:191], v[190:191], v[22:23], v[58:59] op_sel:[0,1,0] op_sel_hi:[1,1,1]
    v_pk_mul_f32 v[60:61], v[28:29], v[22:23] op_sel_hi:[1,0]
    v_pk_fma_f32 v[192:193], v[192:193], v[22:23], v[60:61] op_sel:[0,1,0] op_sel_hi:[1,1,1]
    v_pk_mul_f32 v[62:63], v[30:31], v[22:23] op_sel_hi:[1,0]
    v_pk_fma_f32 v[194:195], v[194:195], v[22:23], v[62:63] op_sel:[0,1,0] op_sel_hi:[1,1,1]
    v_pk_mul_f32 v[56:57], v[188:189], v[188:189]
    v_pk_mul_f32 v[58:59], v[190:191], v[190:191]
    v_pk_mul_f32 v[60:61], v[192:193], v[192:193]
    v_pk_mul_f32 v[62:63], v[194:195], v[194:195]
    v_pk_fma_f32 v[56:57], v[56:57], s[70:71], v[14:15]
    v_pk_fma_f32 v[58:59], v[58:59], s[70:71], v[14:15]
    v_pk_fma_f32 v[60:61], v[60:61], s[70:71], v[14:15]
    v_pk_fma_f32 v[62:63], v[62:63], s[70:71], v[14:15]
    v_pk_mul_f32 v[56:57], v[56:57], v[188:189]
    v_pk_mul_f32 v[58:59], v[58:59], v[190:191]
    v_pk_mul_f32 v[60:61], v[60:61], v[192:193]
    v_pk_mul_f32 v[62:63], v[62:63], v[194:195]
    v_exp_f32 v56, v56
    v_exp_f32 v57, v57
    v_exp_f32 v58, v58
    v_exp_f32 v59, v59
    v_exp_f32 v60, v60
    v_exp_f32 v61, v61
    v_exp_f32 v62, v62
    v_exp_f32 v63, v63
    v_pk_add_f32 v[56:57], v[56:57], 1.0 op_sel_hi:[1,0]
    v_pk_add_f32 v[58:59], v[58:59], 1.0 op_sel_hi:[1,0]
    v_pk_add_f32 v[60:61], v[60:61], 1.0 op_sel_hi:[1,0]
m_kernel_padb19:
    s_cbranch_execz m_kernel_wret2
    v_pk_add_f32 v[62:63], v[62:63], 1.0 op_sel_hi:[1,0]
    v_rcp_f32 v56, v56
    v_rcp_f32 v57, v57
    v_rcp_f32 v58, v58
    v_rcp_f32 v59, v59
    v_rcp_f32 v60, v60
    v_rcp_f32 v61, v61
    v_rcp_f32 v62, v62
    v_rcp_f32 v63, v63
    v_pk_mul_f32 v[188:189], v[188:189], v[56:57]
    v_pk_mul_f32 v[190:191], v[190:191], v[58:59]
    v_pk_mul_f32 v[192:193], v[192:193], v[60:61]
    v_pk_mul_f32 v[194:195], v[194:195], v[62:63]
    v_cvt_pk_bf16_f32 v80, v188, v189
    v_cvt_pk_bf16_f32 v81, v190, v191
    v_cvt_pk_bf16_f32 v82, v192, v193
    v_cvt_pk_bf16_f32 v83, v194, v195
    s_nop 1
    v_permlane16_swap_b32 v80, v82
    v_permlane16_swap_b32 v81, v83
    buffer_store_dwordx4 v[80:83], v8, s[16:19], s44 offen offset:768 sc1
    v_pk_mul_f32 v[64:65], v[32:33], v[22:23] op_sel_hi:[1,0]
    v_pk_fma_f32 v[196:197], v[196:197], v[22:23], v[64:65] op_sel:[0,1,0] op_sel_hi:[1,1,1]
    v_pk_mul_f32 v[66:67], v[34:35], v[22:23] op_sel_hi:[1,0]
    v_pk_fma_f32 v[198:199], v[198:199], v[22:23], v[66:67] op_sel:[0,1,0] op_sel_hi:[1,1,1]
    v_pk_mul_f32 v[68:69], v[36:37], v[22:23] op_sel_hi:[1,0]
    v_pk_fma_f32 v[200:201], v[200:201], v[22:23], v[68:69] op_sel:[0,1,0] op_sel_hi:[1,1,1]
    v_pk_mul_f32 v[70:71], v[38:39], v[22:23] op_sel_hi:[1,0]
    v_pk_fma_f32 v[202:203], v[202:203], v[22:23], v[70:71] op_sel:[0,1,0] op_sel_hi:[1,1,1]
    v_pk_mul_f32 v[64:65], v[196:197], v[196:197]
    v_pk_mul_f32 v[66:67], v[198:199], v[198:199]
    v_pk_mul_f32 v[68:69], v[200:201], v[200:201]
    v_pk_mul_f32 v[70:71], v[202:203], v[202:203]
    v_pk_fma_f32 v[64:65], v[64:65], s[70:71], v[14:15]
    v_pk_fma_f32 v[66:67], v[66:67], s[70:71], v[14:15]
    v_pk_fma_f32 v[68:69], v[68:69], s[70:71], v[14:15]
    v_pk_fma_f32 v[70:71], v[70:71], s[70:71], v[14:15]
    v_pk_mul_f32 v[64:65], v[64:65], v[196:197]
    v_pk_mul_f32 v[66:67], v[66:67], v[198:199]
    v_pk_mul_f32 v[68:69], v[68:69], v[200:201]
    v_pk_mul_f32 v[70:71], v[70:71], v[202:203]
    v_exp_f32 v64, v64
    v_exp_f32 v65, v65
    v_exp_f32 v66, v66
    v_exp_f32 v67, v67
m_kernel_padb20:
    s_cbranch_execz m_kernel_padb21
    v_exp_f32 v68, v68
    v_exp_f32 v69, v69
    v_exp_f32 v70, v70
    v_exp_f32 v71, v71
    v_pk_add_f32 v[64:65], v[64:65], 1.0 op_sel_hi:[1,0]
    v_pk_add_f32 v[66:67], v[66:67], 1.0 op_sel_hi:[1,0]
    v_pk_add_f32 v[68:69], v[68:69], 1.0 op_sel_hi:[1,0]
    v_pk_add_f32 v[70:71], v[70:71], 1.0 op_sel_hi:[1,0]
    v_rcp_f32 v64, v64
    v_rcp_f32 v65, v65
    v_rcp_f32 v66, v66
    v_rcp_f32 v67, v67
    v_rcp_f32 v68, v68
    v_rcp_f32 v69, v69
    v_rcp_f32 v70, v70
    v_rcp_f32 v71, v71
    v_pk_mul_f32 v[196:197], v[196:197], v[64:65]
    v_pk_mul_f32 v[198:199], v[198:199], v[66:67]
    v_pk_mul_f32 v[200:201], v[200:201], v[68:69]
    v_pk_mul_f32 v[202:203], v[202:203], v[70:71]
    v_cvt_pk_bf16_f32 v84, v196, v197
    v_cvt_pk_bf16_f32 v85, v198, v199
    v_cvt_pk_bf16_f32 v86, v200, v201
    v_cvt_pk_bf16_f32 v87, v202, v203
    s_nop 1
    v_permlane16_swap_b32 v84, v86
    v_permlane16_swap_b32 v85, v87
    buffer_store_dwordx4 v[84:87], v9, s[16:19], s44 offen offset:768 sc1
    v_pk_mul_f32 v[56:57], v[40:41], v[22:23] op_sel_hi:[1,0]
    v_pk_fma_f32 v[204:205], v[204:205], v[22:23], v[56:57] op_sel:[0,1,0] op_sel_hi:[1,1,1]
    v_pk_mul_f32 v[58:59], v[42:43], v[22:23] op_sel_hi:[1,0]
    v_pk_fma_f32 v[206:207], v[206:207], v[22:23], v[58:59] op_sel:[0,1,0] op_sel_hi:[1,1,1]
    v_pk_mul_f32 v[60:61], v[44:45], v[22:23] op_sel_hi:[1,0]
    v_pk_fma_f32 v[208:209], v[208:209], v[22:23], v[60:61] op_sel:[0,1,0] op_sel_hi:[1,1,1]
    v_pk_mul_f32 v[62:63], v[46:47], v[22:23] op_sel_hi:[1,0]
    v_pk_fma_f32 v[210:211], v[210:211], v[22:23], v[62:63] op_sel:[0,1,0] op_sel_hi:[1,1,1]
    v_pk_mul_f32 v[56:57], v[204:205], v[204:205]
    v_pk_mul_f32 v[58:59], v[206:207], v[206:207]
    v_pk_mul_f32 v[60:61], v[208:209], v[208:209]
    v_pk_mul_f32 v[62:63], v[210:211], v[210:211]
    v_pk_fma_f32 v[56:57], v[56:57], s[70:71], v[14:15]
    v_pk_fma_f32 v[58:59], v[58:59], s[70:71], v[14:15]
    v_pk_fma_f32 v[60:61], v[60:61], s[70:71], v[14:15]
    v_pk_fma_f32 v[62:63], v[62:63], s[70:71], v[14:15]
    v_pk_mul_f32 v[56:57], v[56:57], v[204:205]
m_kernel_padb21:
    s_cbranch_execz m_kernel_wret2
    v_pk_mul_f32 v[58:59], v[58:59], v[206:207]
    v_pk_mul_f32 v[60:61], v[60:61], v[208:209]
    v_pk_mul_f32 v[62:63], v[62:63], v[210:211]
    v_exp_f32 v56, v56
    v_exp_f32 v57, v57
    v_exp_f32 v58, v58
    v_exp_f32 v59, v59
    v_exp_f32 v60, v60
    v_exp_f32 v61, v61
    v_exp_f32 v62, v62
    v_exp_f32 v63, v63
    v_pk_add_f32 v[56:57], v[56:57], 1.0 op_sel_hi:[1,0]
    v_pk_add_f32 v[58:59], v[58:59], 1.0 op_sel_hi:[1,0]
    v_pk_add_f32 v[60:61], v[60:61], 1.0 op_sel_hi:[1,0]
    v_pk_add_f32 v[62:63], v[62:63], 1.0 op_sel_hi:[1,0]
    v_rcp_f32 v56, v56
    v_rcp_f32 v57, v57
    v_rcp_f32 v58, v58
    v_rcp_f32 v59, v59
    v_rcp_f32 v60, v60
    v_rcp_f32 v61, v61
    v_rcp_f32 v62, v62
    v_rcp_f32 v63, v63
    v_pk_mul_f32 v[204:205], v[204:205], v[56:57]
    v_pk_mul_f32 v[206:207], v[206:207], v[58:59]
    v_pk_mul_f32 v[208:209], v[208:209], v[60:61]
    v_pk_mul_f32 v[210:211], v[210:211], v[62:63]
    v_cvt_pk_bf16_f32 v72, v204, v205
    v_cvt_pk_bf16_f32 v73, v206, v207
    v_cvt_pk_bf16_f32 v74, v208, v209
    v_cvt_pk_bf16_f32 v75, v210, v211
    s_nop 1
    v_permlane16_swap_b32 v72, v74
    v_permlane16_swap_b32 v73, v75
    buffer_store_dwordx4 v[72:75], v10, s[16:19], s44 offen offset:768 sc1
    v_pk_mul_f32 v[64:65], v[48:49], v[20:21] op_sel_hi:[1,0]
    v_pk_fma_f32 v[184:185], v[184:185], v[20:21], v[64:65] op_sel:[0,1,0] op_sel_hi:[1,1,1]
    v_pk_mul_f32 v[66:67], v[50:51], v[20:21] op_sel_hi:[1,0]
    v_pk_fma_f32 v[186:187], v[186:187], v[20:21], v[66:67] op_sel:[0,1,0] op_sel_hi:[1,1,1]
    v_pk_mul_f32 v[68:69], v[48:49], v[22:23] op_sel_hi:[1,0]
    v_pk_fma_f32 v[212:213], v[212:213], v[22:23], v[68:69] op_sel:[0,1,0] op_sel_hi:[1,1,1]
    v_pk_mul_f32 v[70:71], v[50:51], v[22:23] op_sel_hi:[1,0]
    v_pk_fma_f32 v[214:215], v[214:215], v[22:23], v[70:71] op_sel:[0,1,0] op_sel_hi:[1,1,1]
    v_pk_mul_f32 v[64:65], v[184:185], v[184:185]
    v_pk_mul_f32 v[66:67], v[186:187], v[186:187]
    v_pk_mul_f32 v[68:69], v[212:213], v[212:213]
    v_pk_mul_f32 v[70:71], v[214:215], v[214:215]
m_kernel_padb22:
    s_cbranch_execz m_kernel_padb23
    v_pk_fma_f32 v[64:65], v[64:65], s[70:71], v[14:15]
    v_pk_fma_f32 v[66:67], v[66:67], s[70:71], v[14:15]
    v_pk_fma_f32 v[68:69], v[68:69], s[70:71], v[14:15]
    v_pk_fma_f32 v[70:71], v[70:71], s[70:71], v[14:15]
    v_pk_mul_f32 v[64:65], v[64:65], v[184:185]
    v_pk_mul_f32 v[66:67], v[66:67], v[186:187]
    v_pk_mul_f32 v[68:69], v[68:69], v[212:213]
    v_pk_mul_f32 v[70:71], v[70:71], v[214:215]
    v_exp_f32 v64, v64
    v_exp_f32 v65, v65
    v_exp_f32 v66, v66
    v_exp_f32 v67, v67
    v_exp_f32 v68, v68
    v_exp_f32 v69, v69
    v_exp_f32 v70, v70
    v_exp_f32 v71, v71
    v_pk_add_f32 v[64:65], v[64:65], 1.0 op_sel_hi:[1,0]
    v_pk_add_f32 v[66:67], v[66:67], 1.0 op_sel_hi:[1,0]
    v_pk_add_f32 v[68:69], v[68:69], 1.0 op_sel_hi:[1,0]
    v_pk_add_f32 v[70:71], v[70:71], 1.0 op_sel_hi:[1,0]
    v_rcp_f32 v64, v64
    v_rcp_f32 v65, v65
    v_rcp_f32 v66, v66
    v_rcp_f32 v67, v67
    v_rcp_f32 v68, v68
    v_rcp_f32 v69, v69
    v_rcp_f32 v70, v70
    v_rcp_f32 v71, v71
    v_pk_mul_f32 v[184:185], v[184:185], v[64:65]
    v_pk_mul_f32 v[186:187], v[186:187], v[66:67]
    v_pk_mul_f32 v[212:213], v[212:213], v[68:69]
    v_pk_mul_f32 v[214:215], v[214:215], v[70:71]
    v_cvt_pk_bf16_f32 v76, v184, v185
    v_cvt_pk_bf16_f32 v77, v186, v187
    v_cvt_pk_bf16_f32 v78, v212, v213
    v_cvt_pk_bf16_f32 v79, v214, v215
    s_nop 1
    v_permlane16_swap_b32 v76, v78
    v_permlane16_swap_b32 v77, v79
    buffer_store_dwordx4 v[76:79], v12, s[16:19], s44 offen offset:512 sc1
    s_nop 1
    v_and_b32 v2, 15, v1
    v_add_u32 v2, s48, v2
    v_lshrrev_b32 v3, 4, v1
    v_lshlrev_b32 v3, 11, v3
    v_lshl_add_u32 v2, v2, 4, v3
    v_add_u32 v6, 106496, v2
    v_add_u32 v7, 114688, v2
    v_lshrrev_b32 v2, 4, v1
    v_bfe_u32 v3, v1, 2, 2
m_kernel_padb23:
    s_cbranch_execz m_kernel_wret2
    v_lshl_add_u32 v4, v2, 3, v3
    v_lshlrev_b32 v4, 7, v4
    v_bfe_u32 v5, v1, 3, 2
    v_lshl_add_u32 v4, v5, 5, v4
    v_and_b32 v3, 3, v1
    v_lshl_add_u32 v4, v3, 3, v4
    v_add_u32 v8, 122880, v4
    v_xor_b32 v9, 32, v8
    v_xor_b32 v10, 64, v8
    v_xor_b32 v11, 96, v8
    s_mov_b32 s52, 0
    s_mov_b32 s50, 98304
    s_mov_b32 s53, 24576
    s_barrier
    ds_read_b128 v[16:19], v6 offset:0
    ds_read_b64_tr_b16 v[24:25], v8 offset:0
    ds_read_b64_tr_b16 v[26:27], v8 offset:512
    ds_read_b64_tr_b16 v[28:29], v9 offset:0
    ds_read_b64_tr_b16 v[30:31], v9 offset:512
    ds_read_b64_tr_b16 v[32:33], v10 offset:0
    ds_read_b64_tr_b16 v[34:35], v10 offset:512
    ds_read_b64_tr_b16 v[36:37], v11 offset:0
    ds_read_b64_tr_b16 v[38:39], v11 offset:512
    ds_read_b128 v[20:23], v6 offset:256
    .p2align 4
m_kernel_c4a:
    s_waitcnt lgkmcnt(0)
    v_mfma_f32_16x16x32_bf16 v[216:219], v[24:27], v[16:19], v[216:219]
    ds_read_b128 v[40:43], v7 offset:0
    ds_read_b64_tr_b16 v[48:49], v8 offset:4096
    v_mfma_f32_16x16x32_bf16 v[232:235], v[24:27], v[20:23], v[232:235]
    ds_read_b64_tr_b16 v[50:51], v8 offset:4608
    ds_read_b64_tr_b16 v[52:53], v9 offset:4096
    v_mfma_f32_16x16x32_bf16 v[220:223], v[28:31], v[16:19], v[220:223]
    ds_read_b64_tr_b16 v[54:55], v9 offset:4608
    ds_read_b64_tr_b16 v[56:57], v10 offset:4096
    v_mfma_f32_16x16x32_bf16 v[236:239], v[28:31], v[20:23], v[236:239]
    ds_read_b64_tr_b16 v[58:59], v10 offset:4608
    ds_read_b64_tr_b16 v[60:61], v11 offset:4096
    v_mfma_f32_16x16x32_bf16 v[224:227], v[32:35], v[16:19], v[224:227]
    ds_read_b64_tr_b16 v[62:63], v11 offset:4608
    ds_read_b128 v[44:47], v7 offset:256
    v_mfma_f32_16x16x32_bf16 v[240:243], v[32:35], v[20:23], v[240:243]
    s_add_u32 s50, s50, 24576
    s_cmp_ge_u32 s50, 147456
    v_mfma_f32_16x16x32_bf16 v[228:231], v[36:39], v[16:19], v[228:231]
    s_cselect_b32 s51, 0xfffe2000, s53
    s_cselect_b32 s50, 0, s50
    v_mfma_f32_16x16x32_bf16 v[244:247], v[36:39], v[20:23], v[244:247]
    v_add_u32 v6, s51, v6
    s_waitcnt lgkmcnt(0)
    v_mfma_f32_16x16x32_bf16 v[216:219], v[48:51], v[40:43], v[216:219]
    s_barrier
    v_add_u32 v8, s51, v8
    v_add_u32 v9, s51, v9
    v_add_u32 v10, s51, v10
    v_add_u32 v11, s51, v11
    ds_read_b128 v[16:19], v6 offset:0
    v_mfma_f32_16x16x32_bf16 v[232:235], v[48:51], v[44:47], v[232:235]
    ds_read_b64_tr_b16 v[24:25], v8 offset:0
    ds_read_b64_tr_b16 v[26:27], v8 offset:512
    v_mfma_f32_16x16x32_bf16 v[220:223], v[52:55], v[40:43], v[220:223]
    ds_read_b64_tr_b16 v[28:29], v9 offset:0
    ds_read_b64_tr_b16 v[30:31], v9 offset:512
    v_mfma_f32_16x16x32_bf16 v[236:239], v[52:55], v[44:47], v[236:239]
    ds_read_b64_tr_b16 v[32:33], v10 offset:0
    ds_read_b64_tr_b16 v[34:35], v10 offset:512
    v_mfma_f32_16x16x32_bf16 v[224:227], v[56:59], v[40:43], v[224:227]
    ds_read_b64_tr_b16 v[36:37], v11 offset:0
    ds_read_b64_tr_b16 v[38:39], v11 offset:512
    v_mfma_f32_16x16x32_bf16 v[240:243], v[56:59], v[44:47], v[240:243]
    ds_read_b128 v[20:23], v6 offset:256
    v_add_u32 v7, s51, v7
    v_mfma_f32_16x16x32_bf16 v[228:231], v[60:63], v[40:43], v[228:231]
    s_add_u32 s52, s52, 1
    v_mfma_f32_16x16x32_bf16 v[244:247], v[60:63], v[44:47], v[244:247]
    s_cmp_lt_u32 s52, 4
    s_cbranch_scc1 m_kernel_c4a
m_kernel_padb24:
    s_cbranch_execz m_kernel_padb25
    s_waitcnt vmcnt(0)
    s_add_u32 s40, s34, 16384
    s_mov_b64 exec, 1
    v_mov_b32 v2, s5
    buffer_store_dword v2, off, s[16:19], s40 sc1
    s_mov_b64 exec, -1
    buffer_load_dwordx4 v[96:99], v248, s[20:23], 0 offen offset:0
    buffer_load_dwordx4 v[100:103], v248, s[20:23], 0 offen offset:64
    buffer_load_dwordx4 v[104:107], v249, s[20:23], 0 offen offset:0
    buffer_load_dwordx4 v[108:111], v249, s[20:23], 0 offen offset:64
    s_mov_b32 s52, 0
    .p2align 4
m_kernel_c4b:
    s_waitcnt lgkmcnt(0)
    v_mfma_f32_16x16x32_bf16 v[216:219], v[24:27], v[16:19], v[216:219]
    ds_read_b128 v[40:43], v7 offset:0
    ds_read_b64_tr_b16 v[48:49], v8 offset:4096
    v_mfma_f32_16x16x32_bf16 v[232:235], v[24:27], v[20:23], v[232:235]
    ds_read_b64_tr_b16 v[50:51], v8 offset:4608
    ds_read_b64_tr_b16 v[52:53], v9 offset:4096
    v_mfma_f32_16x16x32_bf16 v[220:223], v[28:31], v[16:19], v[220:223]
    ds_read_b64_tr_b16 v[54:55], v9 offset:4608
    ds_read_b64_tr_b16 v[56:57], v10 offset:4096
    v_mfma_f32_16x16x32_bf16 v[236:239], v[28:31], v[20:23], v[236:239]
    ds_read_b64_tr_b16 v[58:59], v10 offset:4608
    ds_read_b64_tr_b16 v[60:61], v11 offset:4096
    v_mfma_f32_16x16x32_bf16 v[224:227], v[32:35], v[16:19], v[224:227]
    ds_read_b64_tr_b16 v[62:63], v11 offset:4608
    ds_read_b128 v[44:47], v7 offset:256
    v_mfma_f32_16x16x32_bf16 v[240:243], v[32:35], v[20:23], v[240:243]
    s_add_u32 s50, s50, 24576
    s_cmp_ge_u32 s50, 147456
    v_mfma_f32_16x16x32_bf16 v[228:231], v[36:39], v[16:19], v[228:231]
    s_cselect_b32 s51, 0xfffe2000, s53
    s_cselect_b32 s50, 0, s50
    v_mfma_f32_16x16x32_bf16 v[244:247], v[36:39], v[20:23], v[244:247]
    v_add_u32 v6, s51, v6
    s_waitcnt lgkmcnt(0)
    v_mfma_f32_16x16x32_bf16 v[216:219], v[48:51], v[40:43], v[216:219]
    s_barrier
    v_add_u32 v8, s51, v8
    v_add_u32 v9, s51, v9
    v_add_u32 v10, s51, v10
    v_add_u32 v11, s51, v11
    ds_read_b128 v[16:19], v6 offset:0
    v_mfma_f32_16x16x32_bf16 v[232:235], v[48:51], v[44:47], v[232:235]
    ds_read_b64_tr_b16 v[24:25], v8 offset:0
    ds_read_b64_tr_b16 v[26:27], v8 offset:512
    v_mfma_f32_16x16x32_bf16 v[220:223], v[52:55], v[40:43], v[220:223]
    ds_read_b64_tr_b16 v[28:29], v9 offset:0
    ds_read_b64_tr_b16 v[30:31], v9 offset:512
    v_mfma_f32_16x16x32_bf16 v[236:239], v[52:55], v[44:47], v[236:239]
    ds_read_b64_tr_b16 v[32:33], v10 offset:0
    ds_read_b64_tr_b16 v[34:35], v10 offset:512
    v_mfma_f32_16x16x32_bf16 v[224:227], v[56:59], v[40:43], v[224:227]
    ds_read_b64_tr_b16 v[36:37], v11 offset:0
    ds_read_b64_tr_b16 v[38:39], v11 offset:512
    v_mfma_f32_16x16x32_bf16 v[240:243], v[56:59], v[44:47], v[240:243]
    ds_read_b128 v[20:23], v6 offset:256
    v_add_u32 v7, s51, v7
    v_mfma_f32_16x16x32_bf16 v[228:231], v[60:63], v[40:43], v[228:231]
    s_add_u32 s52, s52, 1
    v_mfma_f32_16x16x32_bf16 v[244:247], v[60:63], v[44:47], v[244:247]
    s_cmp_lt_u32 s52, 61
    s_cbranch_scc1 m_kernel_c4b
m_kernel_padb25:
    s_cbranch_execz m_kernel_wret2
    s_waitcnt vmcnt(0) lgkmcnt(0)
    s_nop 7
    s_nop 1
    v_permlane16_swap_b32 v216, v220
    v_permlane16_swap_b32 v217, v221
    v_permlane16_swap_b32 v218, v222
    v_permlane16_swap_b32 v219, v223
    v_lshlrev_b32 v2, 16, v96
    v_and_b32 v3, 0xffff0000, v96
    v_pk_add_f32 v[216:217], v[216:217], v[2:3]
    v_lshlrev_b32 v2, 16, v97
    v_and_b32 v3, 0xffff0000, v97
    v_pk_add_f32 v[218:219], v[218:219], v[2:3]
    v_lshlrev_b32 v2, 16, v98
    v_and_b32 v3, 0xffff0000, v98
    v_pk_add_f32 v[220:221], v[220:221], v[2:3]
    v_lshlrev_b32 v2, 16, v99
    v_and_b32 v3, 0xffff0000, v99
    v_pk_add_f32 v[222:223], v[222:223], v[2:3]
    v_cvt_pk_bf16_f32 v96, v216, v217
    v_cvt_pk_bf16_f32 v97, v218, v219
    v_cvt_pk_bf16_f32 v98, v220, v221
    v_cvt_pk_bf16_f32 v99, v222, v223
    buffer_store_dwordx4 v[96:99], v248, s[24:27], 0 offen offset:0
    v_permlane16_swap_b32 v224, v228
    v_permlane16_swap_b32 v225, v229
    v_permlane16_swap_b32 v226, v230
    v_permlane16_swap_b32 v227, v231
    v_lshlrev_b32 v2, 16, v100
    v_and_b32 v3, 0xffff0000, v100
    v_pk_add_f32 v[224:225], v[224:225], v[2:3]
    v_lshlrev_b32 v2, 16, v101
    v_and_b32 v3, 0xffff0000, v101
    v_pk_add_f32 v[226:227], v[226:227], v[2:3]
    v_lshlrev_b32 v2, 16, v102
    v_and_b32 v3, 0xffff0000, v102
    v_pk_add_f32 v[228:229], v[228:229], v[2:3]
    v_lshlrev_b32 v2, 16, v103
    v_and_b32 v3, 0xffff0000, v103
    v_pk_add_f32 v[230:231], v[230:231], v[2:3]
    v_cvt_pk_bf16_f32 v100, v224, v225
    v_cvt_pk_bf16_f32 v101, v226, v227
    v_cvt_pk_bf16_f32 v102, v228, v229
    v_cvt_pk_bf16_f32 v103, v230, v231
    buffer_store_dwordx4 v[100:103], v248, s[24:27], 0 offen offset:64
    v_permlane16_swap_b32 v232, v236
    v_permlane16_swap_b32 v233, v237
    v_permlane16_swap_b32 v234, v238
    v_permlane16_swap_b32 v235, v239
m_kernel_padb26:
    s_cbranch_execz m_kernel_wret2
    v_lshlrev_b32 v2, 16, v104
    v_and_b32 v3, 0xffff0000, v104
    v_pk_add_f32 v[232:233], v[232:233], v[2:3]
    v_lshlrev_b32 v2, 16, v105
    v_and_b32 v3, 0xffff0000, v105
    v_pk_add_f32 v[234:235], v[234:235], v[2:3]
    v_lshlrev_b32 v2, 16, v106
    v_and_b32 v3, 0xffff0000, v106
    v_pk_add_f32 v[236:237], v[236:237], v[2:3]
    v_lshlrev_b32 v2, 16, v107
    v_and_b32 v3, 0xffff0000, v107
    v_pk_add_f32 v[238:239], v[238:239], v[2:3]
    v_cvt_pk_bf16_f32 v104, v232, v233
    v_cvt_pk_bf16_f32 v105, v234, v235
    v_cvt_pk_bf16_f32 v106, v236, v237
    v_cvt_pk_bf16_f32 v107, v238, v239
    buffer_store_dwordx4 v[104:107], v249, s[24:27], 0 offen offset:0
    v_permlane16_swap_b32 v240, v244
    v_permlane16_swap_b32 v241, v245
    v_permlane16_swap_b32 v242, v246
    v_permlane16_swap_b32 v243, v247
    v_lshlrev_b32 v2, 16, v108
    v_and_b32 v3, 0xffff0000, v108
    v_pk_add_f32 v[240:241], v[240:241], v[2:3]
    v_lshlrev_b32 v2, 16, v109
    v_and_b32 v3, 0xffff0000, v109
    v_pk_add_f32 v[242:243], v[242:243], v[2:3]
    v_lshlrev_b32 v2, 16, v110
    v_and_b32 v3, 0xffff0000, v110
    v_pk_add_f32 v[244:245], v[244:245], v[2:3]
    v_lshlrev_b32 v2, 16, v111
    v_and_b32 v3, 0xffff0000, v111
    v_pk_add_f32 v[246:247], v[246:247], v[2:3]
    v_cvt_pk_bf16_f32 v108, v240, v241
    v_cvt_pk_bf16_f32 v109, v242, v243
    v_cvt_pk_bf16_f32 v110, v244, v245
    v_cvt_pk_bf16_f32 v111, v246, v247
    buffer_store_dwordx4 v[108:111], v249, s[24:27], 0 offen offset:64
m_kernel_end:
    s_endpgm
.section .rodata,"a"
.p2align 6
.amdhsa_kernel m_kernel
  .amdhsa_next_free_vgpr 256
  .amdhsa_next_free_sgpr 100
  .amdhsa_accum_offset 256
  .amdhsa_group_segment_fixed_size 0
  .amdhsa_kernarg_size 88
  .amdhsa_user_sgpr_count 2
  .amdhsa_user_sgpr_kernarg_segment_ptr 1
  .amdhsa_system_sgpr_workgroup_id_x 1
.end_amdhsa_kernel
```
